```python
import torch

def _softmax(x, axis=-1):
    return torch.softmax(x, dim=axis)
def _gelu(x):
    return torch.nn.functional.gelu(x, approximate="tanh")
def _silu(x):
    return torch.nn.functional.silu(x)
def _sigmoid(x):
    return torch.sigmoid(x)
def _layernorm(x, axis=-1, eps=1e-5):
    m = x.mean(dim=axis, keepdim=True)
    v = x.var(dim=axis, keepdim=True, unbiased=False)
    return (x - m) / torch.sqrt(v + eps)
def _scatter_add(tgt, idx, src, axis=0):
    return tgt.clone().index_add_(axis, idx, src)
def _segment_sum(src, seg, n):
    out = torch.zeros((n,) + src.shape[1:], dtype=src.dtype)
    return out.index_add_(0, seg, src)
def _pad(x, pw):
    flat = tuple(v for pair in reversed(pw) for v in pair)
    return torch.nn.functional.pad(x, flat)

kernel_name = 'gated_mix__softmax_full_mha__swiglu_ffn__prompt'

def setup_inputs():

    _w = (lambda a: (lambda t: t.to(torch.bfloat16) if t.is_floating_point() else t)(torch.as_tensor(a)))
    def _A_setup():
        B, S, D = 1, 2048, 512
        return {
            "x": _w((lambda *s: torch.randn(*s, dtype=torch.bfloat16) * 0.05)(B, S, D)),
            "wqkv": _w((lambda *s: torch.randn(*s, dtype=torch.bfloat16) * 0.8)(D, 3 * D)),
            "wo": _w((lambda *s: torch.randn(*s, dtype=torch.bfloat16) * 0.05)(D, D)),
        }
    _A_in = _A_setup()

    def _B_setup():
        B, S, D, F = 1, 2048, 512, 1376
        return {
            "x": _w((lambda *s: torch.randn(*s, dtype=torch.bfloat16) * 0.05)(B, S, D)),
            "w_gate": _w((lambda *s: torch.randn(*s, dtype=torch.bfloat16) * 0.1)(D, F)),
            "w_up": _w((lambda *s: torch.randn(*s, dtype=torch.bfloat16) * 0.1)(D, F)),
            "w_down": _w((lambda *s: torch.randn(*s, dtype=torch.bfloat16) * 0.1)(F, D)),
        }
    _B_in = _B_setup()

    return {
        "A_x": _A_in["x"],
        "A_wqkv": _A_in["wqkv"],
        "A_wo": _A_in["wo"],
        "B_x": _B_in["x"],
        "B_w_gate": _B_in["w_gate"],
        "B_w_up": _B_in["w_up"],
        "B_w_down": _B_in["w_down"],
        "gate_w": _w((lambda *s: torch.randn(*s, dtype=torch.bfloat16) * 0.05)(512) * 16.0),
    }

def reference(A_x, A_wqkv, A_wo, B_x, B_w_gate, B_w_up, B_w_down, gate_w):
    def _A_ref(x, wqkv, wo):
        B, S, D = x.shape
        H = 32; Dh = D // H
        qkv = (lambda x, *d: x.permute(*d))((x @ wqkv).reshape(B, S, 3, H, Dh), 2, 0, 3, 1, 4)
        q, k, v = qkv[0], qkv[1], qkv[2]
        scale = Dh ** -0.5
        scores = torch.einsum("bhqd,bhkd->bhqk", q, k) * scale
        p = _softmax(scores, axis=-1)
        o = torch.einsum("bhqk,bhkd->bhqd", p, v)
        return (lambda x, *d: x.permute(*d))(o, 0, 2, 1, 3).reshape(B, S, D) @ wo

    def _B_ref(x, w_gate, w_up, w_down):
        g = _silu(x @ w_gate)
        u = x @ w_up
        return (g * u) @ w_down

    x = A_x
    g = _sigmoid((x * gate_w).sum(-1, keepdims=True))
    a = _A_ref(x, A_wqkv, A_wo)
    b = _B_ref(x, B_w_gate, B_w_up, B_w_down)
    return g * a + (1 - g) * b
```

```asm
; @launch kernel=k1_qkv_kernel grid=(256,1,1) block=(768,1,1) lds=159744
; @launch kernel=k2_attn_kernel grid=(256,1,1) block=(768,1,1) lds=148480
; @launch kernel=gated_mix__softmax_full_mha__swiglu_ffn__prompt_kernel grid=(256,1,1) block=(256,1,1) lds=49152
.amdgcn_target "amdgcn-amd-amdhsa--gfx950"
.text
.globl k1_qkv_kernel
.p2align 8
.type k1_qkv_kernel,@function
k1_qkv_kernel:
  s_cmp_ge_u32 s2, 256
  s_cbranch_scc1 k1_qkv_kernel_end
  s_load_dwordx16 s[4:19], s[0:1], 0
  s_load_dwordx2 s[24:25], s[0:1], 80
  v_and_b32 v1, 63, v0
  v_lshrrev_b32 v2, 6, v0
  s_nop 0
  v_readfirstlane_b32 s47, v2
  s_and_b32 s49, s2, 7
  s_lshr_b32 s50, s2, 3
  s_and_b32 s51, s49, 1
  s_lshl_b32 s51, s51, 3
  s_and_b32 s52, s50, 7
  s_add_u32 s51, s51, s52
  s_lshr_b32 s52, s49, 1
  s_lshl_b32 s52, s52, 2
  s_lshr_b32 s53, s50, 3
  s_add_u32 s52, s52, s53
  v_lshlrev_b32 v14, 4, v1
  s_and_b32 s48, s47, 3
  s_and_b32 s53, s52, 11
  s_cmp_eq_u32 s53, 11
  s_cselect_b32 s53, 4, 0
  s_xor_b32 s52, s52, s53
  s_cmp_ge_u32 s47, 8
  s_cbranch_scc1 k1_qkv_kernel_loader
  v_and_b32 v13, 31, v1
  v_lshrrev_b32 v15, 5, v1
  v_lshrrev_b32 v2, 1, v13
  v_and_b32 v2, 7, v2
  s_lshl_b32 s53, s48, 12
  v_lshlrev_b32 v3, 7, v13
  v_add_u32 v3, s53, v3
  v_add_u32 v4, 0, v15
  v_xor_b32 v4, v4, v2
  v_lshl_add_u32 v8, v4, 4, v3
  v_add_u32 v4, 2, v15
  v_xor_b32 v4, v4, v2
  v_lshl_add_u32 v9, v4, 4, v3
  v_add_u32 v4, 4, v15
  v_xor_b32 v4, v4, v2
  v_lshl_add_u32 v10, v4, 4, v3
  v_add_u32 v4, 6, v15
  v_xor_b32 v4, v4, v2
  v_lshl_add_u32 v11, v4, 4, v3
  v_and_b32 v4, 15, v1
  v_lshrrev_b32 v5, 2, v4
  v_lshl_add_u32 v5, v15, 3, v5
  v_mul_u32_u24 v5, 0xc0, v5
  v_lshrrev_b32 v6, 4, v1
  v_and_b32 v6, 1, v6
  v_lshl_add_u32 v5, v6, 5, v5
  v_and_b32 v4, 3, v4
  v_lshl_add_u32 v5, v4, 3, v5
  v_add_u32 v12, 16384, v5
  s_mov_b32 s60, 0
  s_mov_b32 s61, 0
  s_mov_b32 s72, 0xfffe6000
  s_mov_b32 s73, 53248
  s_lshl_b32 s74, s51, 2
  s_add_u32 s74, s74, s48
  s_cmp_ge_u32 s47, 4
  s_cbranch_scc1 k1_qkv_kernel_typeB
  v_mov_b32 v72, 0
  v_mov_b32 v73, 0
  v_mov_b32 v74, 0
  v_mov_b32 v75, 0
  v_mov_b32 v76, 0
  v_mov_b32 v77, 0
  v_mov_b32 v78, 0
  v_mov_b32 v79, 0
  v_mov_b32 v80, 0
  v_mov_b32 v81, 0
  v_mov_b32 v82, 0
  v_mov_b32 v83, 0
  v_mov_b32 v84, 0
  v_mov_b32 v85, 0
  v_mov_b32 v86, 0
  v_mov_b32 v87, 0
  v_mov_b32 v88, 0
  v_mov_b32 v89, 0
  v_mov_b32 v90, 0
  v_mov_b32 v91, 0
  v_mov_b32 v92, 0
  v_mov_b32 v93, 0
  v_mov_b32 v94, 0
  v_mov_b32 v95, 0
  v_mov_b32 v96, 0
  v_mov_b32 v97, 0
  v_mov_b32 v98, 0
  v_mov_b32 v99, 0
  v_mov_b32 v100, 0
  v_mov_b32 v101, 0
  v_mov_b32 v102, 0
  v_mov_b32 v103, 0
  v_mov_b32 v104, 0
  v_mov_b32 v105, 0
  v_mov_b32 v106, 0
  v_mov_b32 v107, 0
  v_mov_b32 v108, 0
  v_mov_b32 v109, 0
  v_mov_b32 v110, 0
  v_mov_b32 v111, 0
  v_mov_b32 v112, 0
  v_mov_b32 v113, 0
  v_mov_b32 v114, 0
  v_mov_b32 v115, 0
  v_mov_b32 v116, 0
  v_mov_b32 v117, 0
  v_mov_b32 v118, 0
  v_mov_b32 v119, 0
  v_mov_b32 v120, 0
  v_mov_b32 v121, 0
  v_mov_b32 v122, 0
  v_mov_b32 v123, 0
  v_mov_b32 v124, 0
  v_mov_b32 v125, 0
  v_mov_b32 v126, 0
  v_mov_b32 v127, 0
  v_mov_b32 v128, 0
  v_mov_b32 v129, 0
  v_mov_b32 v130, 0
  v_mov_b32 v131, 0
  v_mov_b32 v132, 0
  v_mov_b32 v133, 0
  v_mov_b32 v134, 0
  v_mov_b32 v135, 0
  v_mov_b32 v136, 0
  v_mov_b32 v137, 0
  v_mov_b32 v138, 0
  v_mov_b32 v139, 0
  v_mov_b32 v140, 0
  v_mov_b32 v141, 0
  v_mov_b32 v142, 0
  v_mov_b32 v143, 0
  v_mov_b32 v144, 0
  v_mov_b32 v145, 0
  v_mov_b32 v146, 0
  v_mov_b32 v147, 0
  v_mov_b32 v148, 0
  v_mov_b32 v149, 0
  v_mov_b32 v150, 0
  v_mov_b32 v151, 0
  s_waitcnt lgkmcnt(0)
  s_barrier
  ds_read_b128 v[16:19], v8
  ds_read_b64_tr_b16 v[32:33], v12 offset:0
  ds_read_b64_tr_b16 v[34:35], v12 offset:768
  ds_read_b64_tr_b16 v[36:37], v12 offset:64
  ds_read_b64_tr_b16 v[38:39], v12 offset:832
  ds_read_b64_tr_b16 v[40:41], v12 offset:128
  ds_read_b64_tr_b16 v[42:43], v12 offset:896
  ds_read_b64_tr_b16 v[44:45], v12 offset:12288
  ds_read_b64_tr_b16 v[46:47], v12 offset:13056
  ds_read_b64_tr_b16 v[48:49], v12 offset:24576
  ds_read_b64_tr_b16 v[50:51], v12 offset:25344
  .p2align 6
k1_qkv_kernel_loopA:
  s_waitcnt lgkmcnt(8)
  v_mfma_f32_32x32x16_bf16 v[72:87], v[32:35], v[16:19], v[72:87]
  ds_read_b128 v[20:23], v9
  ds_read_b64_tr_b16 v[52:53], v12 offset:3072
  ds_read_b64_tr_b16 v[54:55], v12 offset:3840
  s_waitcnt lgkmcnt(9)
  v_mfma_f32_32x32x16_bf16 v[88:103], v[36:39], v[16:19], v[88:103]
  ds_read_b64_tr_b16 v[56:57], v12 offset:3136
  ds_read_b64_tr_b16 v[58:59], v12 offset:3904
  ds_read_b64_tr_b16 v[60:61], v12 offset:3200
  s_waitcnt lgkmcnt(10)
  v_mfma_f32_32x32x16_bf16 v[104:119], v[40:43], v[16:19], v[104:119]
  ds_read_b64_tr_b16 v[62:63], v12 offset:3968
  ds_read_b64_tr_b16 v[64:65], v12 offset:15360
  ds_read_b64_tr_b16 v[66:67], v12 offset:16128
  s_waitcnt lgkmcnt(11)
  v_mfma_f32_32x32x16_bf16 v[120:135], v[44:47], v[16:19], v[120:135]
  ds_read_b64_tr_b16 v[68:69], v12 offset:27648
  ds_read_b64_tr_b16 v[70:71], v12 offset:28416
  s_waitcnt lgkmcnt(11)
  v_mfma_f32_32x32x16_bf16 v[136:151], v[48:51], v[16:19], v[136:151]
  s_waitcnt lgkmcnt(8)
  v_mfma_f32_32x32x16_bf16 v[72:87], v[52:55], v[20:23], v[72:87]
  ds_read_b128 v[16:19], v10
  ds_read_b64_tr_b16 v[32:33], v12 offset:6144
  ds_read_b64_tr_b16 v[34:35], v12 offset:6912
  s_waitcnt lgkmcnt(9)
  v_mfma_f32_32x32x16_bf16 v[88:103], v[56:59], v[20:23], v[88:103]
  ds_read_b64_tr_b16 v[36:37], v12 offset:6208
  ds_read_b64_tr_b16 v[38:39], v12 offset:6976
  ds_read_b64_tr_b16 v[40:41], v12 offset:6272
  s_waitcnt lgkmcnt(10)
  v_mfma_f32_32x32x16_bf16 v[104:119], v[60:63], v[20:23], v[104:119]
  ds_read_b64_tr_b16 v[42:43], v12 offset:7040
  ds_read_b64_tr_b16 v[44:45], v12 offset:18432
  ds_read_b64_tr_b16 v[46:47], v12 offset:19200
  s_waitcnt lgkmcnt(11)
  v_mfma_f32_32x32x16_bf16 v[120:135], v[64:67], v[20:23], v[120:135]
  ds_read_b64_tr_b16 v[48:49], v12 offset:30720
  ds_read_b64_tr_b16 v[50:51], v12 offset:31488
  s_waitcnt lgkmcnt(11)
  v_mfma_f32_32x32x16_bf16 v[136:151], v[68:71], v[20:23], v[136:151]
  s_waitcnt lgkmcnt(8)
  v_mfma_f32_32x32x16_bf16 v[72:87], v[32:35], v[16:19], v[72:87]
  ds_read_b128 v[20:23], v11
  ds_read_b64_tr_b16 v[52:53], v12 offset:9216
  ds_read_b64_tr_b16 v[54:55], v12 offset:9984
  s_waitcnt lgkmcnt(9)
  v_mfma_f32_32x32x16_bf16 v[88:103], v[36:39], v[16:19], v[88:103]
  ds_read_b64_tr_b16 v[56:57], v12 offset:9280
  ds_read_b64_tr_b16 v[58:59], v12 offset:10048
  ds_read_b64_tr_b16 v[60:61], v12 offset:9344
  s_waitcnt lgkmcnt(10)
  v_mfma_f32_32x32x16_bf16 v[104:119], v[40:43], v[16:19], v[104:119]
  ds_read_b64_tr_b16 v[62:63], v12 offset:10112
  ds_read_b64_tr_b16 v[64:65], v12 offset:21504
  ds_read_b64_tr_b16 v[66:67], v12 offset:22272
  s_waitcnt lgkmcnt(11)
  v_mfma_f32_32x32x16_bf16 v[120:135], v[44:47], v[16:19], v[120:135]
  ds_read_b64_tr_b16 v[68:69], v12 offset:33792
  ds_read_b64_tr_b16 v[70:71], v12 offset:34560
  s_waitcnt lgkmcnt(11)
  v_mfma_f32_32x32x16_bf16 v[136:151], v[48:51], v[16:19], v[136:151]
  s_waitcnt lgkmcnt(0)
  v_mfma_f32_32x32x16_bf16 v[72:87], v[52:55], v[20:23], v[72:87]
  s_barrier
  s_add_u32 s61, s61, 1
  s_cmp_eq_u32 s61, 3
  s_cselect_b32 s62, s72, s73
  s_cselect_b32 s61, 0, s61
  v_add_u32 v8, s62, v8
  v_add_u32 v9, s62, v9
  v_add_u32 v10, s62, v10
  v_add_u32 v11, s62, v11
  v_add_u32 v12, s62, v12
  ds_read_b128 v[16:19], v8
  ds_read_b64_tr_b16 v[32:33], v12 offset:0
  ds_read_b64_tr_b16 v[34:35], v12 offset:768
  v_mfma_f32_32x32x16_bf16 v[88:103], v[56:59], v[20:23], v[88:103]
  ds_read_b64_tr_b16 v[36:37], v12 offset:64
  ds_read_b64_tr_b16 v[38:39], v12 offset:832
  ds_read_b64_tr_b16 v[40:41], v12 offset:128
  v_mfma_f32_32x32x16_bf16 v[104:119], v[60:63], v[20:23], v[104:119]
  ds_read_b64_tr_b16 v[42:43], v12 offset:896
  ds_read_b64_tr_b16 v[44:45], v12 offset:12288
  ds_read_b64_tr_b16 v[46:47], v12 offset:13056
  v_mfma_f32_32x32x16_bf16 v[120:135], v[64:67], v[20:23], v[120:135]
  ds_read_b64_tr_b16 v[48:49], v12 offset:24576
  ds_read_b64_tr_b16 v[50:51], v12 offset:25344
  v_mfma_f32_32x32x16_bf16 v[136:151], v[68:71], v[20:23], v[136:151]
  s_add_u32 s60, s60, 1
  s_cmp_lt_u32 s60, 6
  s_cbranch_scc1 k1_qkv_kernel_loopA
  v_add_u32 v13, 53248, v12
  s_waitcnt lgkmcnt(8)
  v_mfma_f32_32x32x16_bf16 v[72:87], v[32:35], v[16:19], v[72:87]
  ds_read_b128 v[20:23], v9
  ds_read_b128 v[24:27], v10
  ds_read_b128 v[28:31], v11
  ds_read_b64_tr_b16 v[52:53], v12 offset:15360
  s_waitcnt lgkmcnt(10)
  v_mfma_f32_32x32x16_bf16 v[88:103], v[36:39], v[16:19], v[88:103]
  ds_read_b64_tr_b16 v[54:55], v12 offset:16128
  ds_read_b64_tr_b16 v[56:57], v12 offset:27648
  ds_read_b64_tr_b16 v[58:59], v12 offset:28416
  s_waitcnt lgkmcnt(11)
  v_mfma_f32_32x32x16_bf16 v[104:119], v[40:43], v[16:19], v[104:119]
  ds_read_b64_tr_b16 v[60:61], v12 offset:18432
  ds_read_b64_tr_b16 v[62:63], v12 offset:19200
  ds_read_b64_tr_b16 v[64:65], v12 offset:30720
  s_waitcnt lgkmcnt(12)
  v_mfma_f32_32x32x16_bf16 v[120:135], v[44:47], v[16:19], v[120:135]
  ds_read_b64_tr_b16 v[66:67], v12 offset:31488
  ds_read_b64_tr_b16 v[68:69], v12 offset:21504
  ds_read_b64_tr_b16 v[70:71], v12 offset:22272
  s_waitcnt lgkmcnt(13)
  v_mfma_f32_32x32x16_bf16 v[136:151], v[48:51], v[16:19], v[136:151]
  s_mov_b32 s36, s24
  s_and_b32 s37, s25, 0xffff
  s_mov_b32 s38, 33554432
  s_mov_b32 s39, 0x00020000
  s_mov_b32 s76, 0xbfb8aa3b
  s_mov_b32 s77, 0xbfb8aa3b
  s_mov_b32 s78, 1.0
  s_mov_b32 s79, 1.0
  s_add_u32 s58, s74, 0
  s_mul_i32 s58, s74, 118
  s_add_u32 s58, s58, 32
  v_and_b32 v2, 31, v1
  v_lshlrev_b32 v2, 5, v2
  v_lshrrev_b32 v3, 5, v1
  v_lshl_add_u32 v2, v3, 4, v2
  s_waitcnt lgkmcnt(8)
  v_mfma_f32_32x32x16_bf16 v[120:135], v[52:55], v[20:23], v[120:135]
  ds_read_b64_tr_b16 v[32:33], v12 offset:33792
  ds_read_b64_tr_b16 v[34:35], v12 offset:34560
  s_waitcnt lgkmcnt(8)
  v_mfma_f32_32x32x16_bf16 v[136:151], v[56:59], v[20:23], v[136:151]
  s_waitcnt lgkmcnt(6)
  v_mfma_f32_32x32x16_bf16 v[120:135], v[60:63], v[24:27], v[120:135]
  s_waitcnt lgkmcnt(4)
  v_mfma_f32_32x32x16_bf16 v[136:151], v[64:67], v[24:27], v[136:151]
  s_barrier
  v_add_u32 v8, 53248, v8
  v_add_u32 v9, 53248, v9
  v_add_u32 v10, 53248, v10
  v_add_u32 v11, 53248, v11
  ds_read_b128 v[16:19], v8
  ds_read_b128 v[152:155], v9
  ds_read_b128 v[156:159], v10
  ds_read_b128 v[160:163], v11
  ds_read_b64_tr_b16 v[36:37], v13 offset:12288
  ds_read_b64_tr_b16 v[38:39], v13 offset:13056
  ds_read_b64_tr_b16 v[40:41], v13 offset:24576
  ds_read_b64_tr_b16 v[42:43], v13 offset:25344
  ds_read_b64_tr_b16 v[44:45], v13 offset:15360
  ds_read_b64_tr_b16 v[46:47], v13 offset:16128
  s_waitcnt lgkmcnt(12)
  v_mfma_f32_32x32x16_bf16 v[120:135], v[68:71], v[28:31], v[120:135]
  ds_read_b64_tr_b16 v[48:49], v13 offset:27648
  ds_read_b64_tr_b16 v[50:51], v13 offset:28416
  s_waitcnt lgkmcnt(12)
  v_mfma_f32_32x32x16_bf16 v[136:151], v[32:35], v[28:31], v[136:151]
  ds_read_b64_tr_b16 v[52:53], v13 offset:18432
  ds_read_b64_tr_b16 v[54:55], v13 offset:19200
  s_waitcnt lgkmcnt(8)
  v_mfma_f32_32x32x16_bf16 v[120:135], v[36:39], v[16:19], v[120:135]
  ds_read_b64_tr_b16 v[56:57], v13 offset:30720
  ds_read_b64_tr_b16 v[58:59], v13 offset:31488
  s_waitcnt lgkmcnt(8)
  v_mfma_f32_32x32x16_bf16 v[136:151], v[40:43], v[16:19], v[136:151]
  ds_read_b64_tr_b16 v[60:61], v13 offset:21504
  ds_read_b64_tr_b16 v[62:63], v13 offset:22272
  s_waitcnt lgkmcnt(8)
  v_mfma_f32_32x32x16_bf16 v[120:135], v[44:47], v[152:155], v[120:135]
  ds_read_b64_tr_b16 v[64:65], v13 offset:33792
  ds_read_b64_tr_b16 v[66:67], v13 offset:34560
  s_waitcnt lgkmcnt(8)
  v_mfma_f32_32x32x16_bf16 v[136:151], v[48:51], v[152:155], v[136:151]
  ds_read_b64_tr_b16 v[68:69], v12 offset:3072
  ds_read_b64_tr_b16 v[70:71], v12 offset:3840
  s_waitcnt lgkmcnt(8)
  v_mfma_f32_32x32x16_bf16 v[120:135], v[52:55], v[156:159], v[120:135]
  ds_read_b64_tr_b16 v[32:33], v12 offset:6144
  ds_read_b64_tr_b16 v[34:35], v12 offset:6912
  s_waitcnt lgkmcnt(8)
  v_mfma_f32_32x32x16_bf16 v[136:151], v[56:59], v[156:159], v[136:151]
  ds_read_b64_tr_b16 v[36:37], v12 offset:9216
  ds_read_b64_tr_b16 v[38:39], v12 offset:9984
  s_waitcnt lgkmcnt(8)
  v_mfma_f32_32x32x16_bf16 v[120:135], v[60:63], v[160:163], v[120:135]
  ds_read_b64_tr_b16 v[40:41], v13 offset:0
  ds_read_b64_tr_b16 v[42:43], v13 offset:768
  s_waitcnt lgkmcnt(8)
  v_mfma_f32_32x32x16_bf16 v[136:151], v[64:67], v[160:163], v[136:151]
  ds_read_b64_tr_b16 v[44:45], v13 offset:3072
  ds_read_b64_tr_b16 v[46:47], v13 offset:3840
  s_waitcnt lgkmcnt(8)
  v_mfma_f32_32x32x16_bf16 v[72:87], v[68:71], v[20:23], v[72:87]
  ds_read_b64_tr_b16 v[48:49], v13 offset:6144
  ds_read_b64_tr_b16 v[50:51], v13 offset:6912
  s_waitcnt lgkmcnt(8)
  v_mfma_f32_32x32x16_bf16 v[72:87], v[32:35], v[24:27], v[72:87]
  ds_read_b64_tr_b16 v[52:53], v13 offset:9216
  ds_read_b64_tr_b16 v[54:55], v13 offset:9984
  s_waitcnt lgkmcnt(8)
  v_mfma_f32_32x32x16_bf16 v[72:87], v[36:39], v[28:31], v[72:87]
  ds_read_b64_tr_b16 v[56:57], v12 offset:3136
  ds_read_b64_tr_b16 v[58:59], v12 offset:3904
  v_mul_f32 v4, s76, v120
  v_mul_f32 v5, s76, v121
  v_mul_f32 v6, s76, v122
  v_mul_f32 v7, s76, v123
  v_exp_f32 v4, v4
  s_waitcnt lgkmcnt(8)
  v_mfma_f32_32x32x16_bf16 v[72:87], v[40:43], v[16:19], v[72:87]
  ds_read_b64_tr_b16 v[60:61], v12 offset:6208
  ds_read_b64_tr_b16 v[62:63], v12 offset:6976
  v_exp_f32 v5, v5
  v_exp_f32 v6, v6
  v_exp_f32 v7, v7
  v_mul_f32 v120, v120, v136
  v_mul_f32 v121, v121, v137
  s_waitcnt lgkmcnt(8)
  v_mfma_f32_32x32x16_bf16 v[72:87], v[44:47], v[152:155], v[72:87]
  ds_read_b64_tr_b16 v[64:65], v12 offset:9280
  ds_read_b64_tr_b16 v[66:67], v12 offset:10048
  v_mul_f32 v122, v122, v138
  v_mul_f32 v123, v123, v139
  v_add_f32 v4, 1.0, v4
  v_add_f32 v5, 1.0, v5
  v_add_f32 v6, 1.0, v6
  s_waitcnt lgkmcnt(8)
  v_mfma_f32_32x32x16_bf16 v[72:87], v[48:51], v[156:159], v[72:87]
  ds_read_b64_tr_b16 v[68:69], v13 offset:64
  ds_read_b64_tr_b16 v[70:71], v13 offset:832
  v_add_f32 v7, 1.0, v7
  v_rcp_f32 v4, v4
  v_rcp_f32 v5, v5
  v_rcp_f32 v6, v6
  v_rcp_f32 v7, v7
  s_waitcnt lgkmcnt(8)
  v_mfma_f32_32x32x16_bf16 v[72:87], v[52:55], v[160:163], v[72:87]
  ds_read_b64_tr_b16 v[32:33], v13 offset:3136
  ds_read_b64_tr_b16 v[34:35], v13 offset:3904
  s_nop 0
  v_mul_f32 v120, v120, v4
  v_mul_f32 v121, v121, v5
  v_mul_f32 v122, v122, v6
  v_mul_f32 v123, v123, v7
  s_waitcnt lgkmcnt(8)
  v_mfma_f32_32x32x16_bf16 v[88:103], v[56:59], v[20:23], v[88:103]
  ds_read_b64_tr_b16 v[36:37], v13 offset:6208
  ds_read_b64_tr_b16 v[38:39], v13 offset:6976
  v_cvt_pk_bf16_f32 v136, v120, v121
  v_cvt_pk_bf16_f32 v137, v122, v123
  v_mul_f32 v4, s76, v124
  v_mul_f32 v5, s76, v125
  v_mul_f32 v6, s76, v126
  s_waitcnt lgkmcnt(8)
  v_mfma_f32_32x32x16_bf16 v[88:103], v[60:63], v[24:27], v[88:103]
  ds_read_b64_tr_b16 v[40:41], v13 offset:9280
  ds_read_b64_tr_b16 v[42:43], v13 offset:10048
  v_mul_f32 v7, s76, v127
  v_exp_f32 v4, v4
  v_exp_f32 v5, v5
  v_exp_f32 v6, v6
  v_exp_f32 v7, v7
  s_waitcnt lgkmcnt(8)
  v_mfma_f32_32x32x16_bf16 v[88:103], v[64:67], v[28:31], v[88:103]
  ds_read_b64_tr_b16 v[44:45], v12 offset:3200
  ds_read_b64_tr_b16 v[46:47], v12 offset:3968
  v_mul_f32 v124, v124, v140
  v_mul_f32 v125, v125, v141
  v_mul_f32 v126, v126, v142
  v_mul_f32 v127, v127, v143
  v_add_f32 v4, 1.0, v4
  s_waitcnt lgkmcnt(8)
  v_mfma_f32_32x32x16_bf16 v[88:103], v[68:71], v[16:19], v[88:103]
  ds_read_b64_tr_b16 v[48:49], v12 offset:6272
  ds_read_b64_tr_b16 v[50:51], v12 offset:7040
  v_add_f32 v5, 1.0, v5
  v_add_f32 v6, 1.0, v6
  v_add_f32 v7, 1.0, v7
  v_rcp_f32 v4, v4
  v_rcp_f32 v5, v5
  s_waitcnt lgkmcnt(8)
  v_mfma_f32_32x32x16_bf16 v[88:103], v[32:35], v[152:155], v[88:103]
  ds_read_b64_tr_b16 v[52:53], v12 offset:9344
  ds_read_b64_tr_b16 v[54:55], v12 offset:10112
  v_rcp_f32 v6, v6
  v_rcp_f32 v7, v7
  s_nop 0
  v_mul_f32 v124, v124, v4
  v_mul_f32 v125, v125, v5
  s_waitcnt lgkmcnt(8)
  v_mfma_f32_32x32x16_bf16 v[88:103], v[36:39], v[156:159], v[88:103]
  ds_read_b64_tr_b16 v[56:57], v13 offset:128
  ds_read_b64_tr_b16 v[58:59], v13 offset:896
  v_mul_f32 v126, v126, v6
  v_mul_f32 v127, v127, v7
  v_cvt_pk_bf16_f32 v138, v124, v125
  v_cvt_pk_bf16_f32 v139, v126, v127
  v_mul_f32 v4, s76, v128
  s_waitcnt lgkmcnt(8)
  v_mfma_f32_32x32x16_bf16 v[88:103], v[40:43], v[160:163], v[88:103]
  ds_read_b64_tr_b16 v[60:61], v13 offset:3200
  ds_read_b64_tr_b16 v[62:63], v13 offset:3968
  v_mul_f32 v5, s76, v129
  v_mul_f32 v6, s76, v130
  v_mul_f32 v7, s76, v131
  v_exp_f32 v4, v4
  v_exp_f32 v5, v5
  s_waitcnt lgkmcnt(8)
  v_mfma_f32_32x32x16_bf16 v[104:119], v[44:47], v[20:23], v[104:119]
  ds_read_b64_tr_b16 v[64:65], v13 offset:6272
  ds_read_b64_tr_b16 v[66:67], v13 offset:7040
  v_exp_f32 v6, v6
  v_exp_f32 v7, v7
  v_mul_f32 v128, v128, v144
  v_mul_f32 v129, v129, v145
  v_mul_f32 v130, v130, v146
  s_waitcnt lgkmcnt(8)
  v_mfma_f32_32x32x16_bf16 v[104:119], v[48:51], v[24:27], v[104:119]
  ds_read_b64_tr_b16 v[68:69], v13 offset:9344
  ds_read_b64_tr_b16 v[70:71], v13 offset:10112
  v_mul_f32 v131, v131, v147
  v_add_f32 v4, 1.0, v4
  v_add_f32 v5, 1.0, v5
  v_add_f32 v6, 1.0, v6
  v_add_f32 v7, 1.0, v7
  s_waitcnt lgkmcnt(8)
  v_mfma_f32_32x32x16_bf16 v[104:119], v[52:55], v[28:31], v[104:119]
  v_rcp_f32 v4, v4
  v_rcp_f32 v5, v5
  v_rcp_f32 v6, v6
  v_rcp_f32 v7, v7
  s_nop 0
  s_waitcnt lgkmcnt(6)
  v_mfma_f32_32x32x16_bf16 v[104:119], v[56:59], v[16:19], v[104:119]
  v_mul_f32 v128, v128, v4
  v_mul_f32 v129, v129, v5
  v_mul_f32 v130, v130, v6
  v_mul_f32 v131, v131, v7
  v_cvt_pk_bf16_f32 v140, v128, v129
  s_waitcnt lgkmcnt(4)
  v_mfma_f32_32x32x16_bf16 v[104:119], v[60:63], v[152:155], v[104:119]
  v_cvt_pk_bf16_f32 v141, v130, v131
  v_mul_f32 v4, s76, v132
  v_mul_f32 v5, s76, v133
  v_mul_f32 v6, s76, v134
  v_mul_f32 v7, s76, v135
  s_waitcnt lgkmcnt(2)
  v_mfma_f32_32x32x16_bf16 v[104:119], v[64:67], v[156:159], v[104:119]
  v_exp_f32 v4, v4
  v_exp_f32 v5, v5
  v_exp_f32 v6, v6
  v_exp_f32 v7, v7
  v_mul_f32 v132, v132, v148
  s_waitcnt lgkmcnt(0)
  v_mfma_f32_32x32x16_bf16 v[104:119], v[68:71], v[160:163], v[104:119]
  v_mul_f32 v133, v133, v149
  v_mul_f32 v134, v134, v150
  v_mul_f32 v135, v135, v151
  v_add_f32 v4, 1.0, v4
  v_add_f32 v5, 1.0, v5
  s_nop 7
  s_nop 7
  v_add_f32 v6, 1.0, v6
  v_add_f32 v7, 1.0, v7
  v_rcp_f32 v4, v4
  v_rcp_f32 v5, v5
  v_rcp_f32 v6, v6
  v_rcp_f32 v7, v7
  s_nop 0
  v_mul_f32 v132, v132, v4
  v_mul_f32 v133, v133, v5
  v_mul_f32 v134, v134, v6
  v_mul_f32 v135, v135, v7
  v_cvt_pk_bf16_f32 v142, v132, v133
  v_cvt_pk_bf16_f32 v143, v134, v135
  s_mul_i32 s61, s52, 3
  s_add_u32 s61, s61, 0
  s_lshl_b32 s62, s61, 1
  s_add_u32 s62, s62, s58
  s_lshl_b32 s62, s62, 10
  s_add_u32 s62, s62, 6291456
  s_cmp_ge_u32 s61, 43
  s_cbranch_scc1 k1_qkv_kernel_sk0
  buffer_store_dwordx4 v[136:139], v14, s[36:39], s62 offen sc1
  buffer_store_dwordx4 v[140:143], v14, s[36:39], s62 offen offset:1024 sc1
  k1_qkv_kernel_sk0:
  s_mul_i32 s61, s52, 3
  s_add_u32 s61, s61, 0
  s_lshr_b32 s62, s61, 4
  s_and_b32 s63, s61, 15
  s_lshl_b32 s65, s62, 21
  s_lshl_b32 s66, s63, 7
  s_add_u32 s66, s66, s74
  s_lshl_b32 s66, s66, 10
  s_add_u32 s65, s65, s66
  s_cmp_eq_u32 s62, 1
  s_cbranch_scc0 k1_qkv_kernel_nokn0
  v_mul_f32 v4, v72, v72
  v_fmac_f32 v4, v73, v73
  v_fmac_f32 v4, v74, v74
  v_fmac_f32 v4, v75, v75
  v_fmac_f32 v4, v76, v76
  v_fmac_f32 v4, v77, v77
  v_fmac_f32 v4, v78, v78
  v_fmac_f32 v4, v79, v79
  v_mov_b32 v6, v4
  s_nop 1
  v_permlane32_swap_b32 v4, v6
  s_nop 1
  v_add_f32 v4, v4, v6
  s_nop 1
  v_max_f32_dpp v4, v4, v4 quad_perm:[1,0,3,2] row_mask:0xf bank_mask:0xf
  s_nop 1
  v_max_f32_dpp v4, v4, v4 quad_perm:[2,3,0,1] row_mask:0xf bank_mask:0xf
  s_nop 1
  v_max_f32_dpp v4, v4, v4 row_half_mirror row_mask:0xf bank_mask:0xf
  s_nop 1
  v_max_f32_dpp v4, v4, v4 row_mirror row_mask:0xf bank_mask:0xf
  s_nop 1
  v_readlane_b32 s68, v4, 0
  v_readlane_b32 s69, v4, 16
  s_nop 1
  v_mov_b32 v7, s68
  v_max_f32 v4, s69, v7
  v_mul_f32 v5, v80, v80
  v_fmac_f32 v5, v81, v81
  v_fmac_f32 v5, v82, v82
  v_fmac_f32 v5, v83, v83
  v_fmac_f32 v5, v84, v84
  v_fmac_f32 v5, v85, v85
  v_fmac_f32 v5, v86, v86
  v_fmac_f32 v5, v87, v87
  v_mov_b32 v6, v5
  s_nop 1
  v_permlane32_swap_b32 v5, v6
  s_nop 1
  v_add_f32 v5, v5, v6
  s_nop 1
  v_max_f32_dpp v5, v5, v5 quad_perm:[1,0,3,2] row_mask:0xf bank_mask:0xf
  s_nop 1
  v_max_f32_dpp v5, v5, v5 quad_perm:[2,3,0,1] row_mask:0xf bank_mask:0xf
  s_nop 1
  v_max_f32_dpp v5, v5, v5 row_half_mirror row_mask:0xf bank_mask:0xf
  s_nop 1
  v_max_f32_dpp v5, v5, v5 row_mirror row_mask:0xf bank_mask:0xf
  s_nop 1
  v_readlane_b32 s68, v5, 0
  v_readlane_b32 s69, v5, 16
  s_nop 1
  v_mov_b32 v7, s68
  v_max_f32 v5, s69, v7
  s_lshl_b32 s67, s63, 7
  s_add_u32 s67, s67, s74
  s_lshl_b32 s67, s67, 2
  s_add_u32 s67, s67, 19939328
  v_mov_b32 v7, 0
  v_cmp_eq_u32 vcc, 0, v1
  s_and_saveexec_b64 s[70:71], vcc
  buffer_store_dword v4, v7, s[36:39], s67 offen
  buffer_store_dword v5, v7, s[36:39], s67 offen offset:256
  s_mov_b64 exec, s[70:71]
  k1_qkv_kernel_nokn0:
  s_cmp_eq_u32 s62, 0
  s_cbranch_scc0 k1_qkv_kernel_nosc0
  s_mov_b32 s80, 0x3eb8aa3b
  s_mov_b32 s81, 0x3eb8aa3b
  v_mul_f32 v72, s80, v72
  v_mul_f32 v73, s80, v73
  v_mul_f32 v74, s80, v74
  v_mul_f32 v75, s80, v75
  v_mul_f32 v76, s80, v76
  v_mul_f32 v77, s80, v77
  v_mul_f32 v78, s80, v78
  v_mul_f32 v79, s80, v79
  v_mul_f32 v80, s80, v80
  v_mul_f32 v81, s80, v81
  v_mul_f32 v82, s80, v82
  v_mul_f32 v83, s80, v83
  v_mul_f32 v84, s80, v84
  v_mul_f32 v85, s80, v85
  v_mul_f32 v86, s80, v86
  v_mul_f32 v87, s80, v87
  k1_qkv_kernel_nosc0:
  v_cvt_pk_bf16_f32 v72, v72, v73
  v_cvt_pk_bf16_f32 v73, v74, v75
  v_cvt_pk_bf16_f32 v74, v76, v77
  v_cvt_pk_bf16_f32 v75, v78, v79
  v_cvt_pk_bf16_f32 v76, v80, v81
  v_cvt_pk_bf16_f32 v77, v82, v83
  v_cvt_pk_bf16_f32 v78, v84, v85
  v_cvt_pk_bf16_f32 v79, v86, v87
  s_cmp_eq_u32 s62, 2
  s_cselect_b64 vcc, -1, 0
  v_cndmask_b32 v3, v14, v2, vcc
  buffer_store_dwordx4 v[72:75], v3, s[36:39], s65 offen sc1
  s_add_u32 s65, s65, 65536
  buffer_store_dwordx4 v[76:79], v3, s[36:39], s65 offen sc1
  s_mul_i32 s61, s52, 3
  s_add_u32 s61, s61, 1
  s_lshr_b32 s62, s61, 4
  s_and_b32 s63, s61, 15
  s_lshl_b32 s65, s62, 21
  s_lshl_b32 s66, s63, 7
  s_add_u32 s66, s66, s74
  s_lshl_b32 s66, s66, 10
  s_add_u32 s65, s65, s66
  s_cmp_eq_u32 s62, 1
  s_cbranch_scc0 k1_qkv_kernel_nokn1
  v_mul_f32 v4, v88, v88
  v_fmac_f32 v4, v89, v89
  v_fmac_f32 v4, v90, v90
  v_fmac_f32 v4, v91, v91
  v_fmac_f32 v4, v92, v92
  v_fmac_f32 v4, v93, v93
  v_fmac_f32 v4, v94, v94
  v_fmac_f32 v4, v95, v95
  v_mov_b32 v6, v4
  s_nop 1
  v_permlane32_swap_b32 v4, v6
  s_nop 1
  v_add_f32 v4, v4, v6
  s_nop 1
  v_max_f32_dpp v4, v4, v4 quad_perm:[1,0,3,2] row_mask:0xf bank_mask:0xf
  s_nop 1
  v_max_f32_dpp v4, v4, v4 quad_perm:[2,3,0,1] row_mask:0xf bank_mask:0xf
  s_nop 1
  v_max_f32_dpp v4, v4, v4 row_half_mirror row_mask:0xf bank_mask:0xf
  s_nop 1
  v_max_f32_dpp v4, v4, v4 row_mirror row_mask:0xf bank_mask:0xf
  s_nop 1
  v_readlane_b32 s68, v4, 0
  v_readlane_b32 s69, v4, 16
  s_nop 1
  v_mov_b32 v7, s68
  v_max_f32 v4, s69, v7
  v_mul_f32 v5, v96, v96
  v_fmac_f32 v5, v97, v97
  v_fmac_f32 v5, v98, v98
  v_fmac_f32 v5, v99, v99
  v_fmac_f32 v5, v100, v100
  v_fmac_f32 v5, v101, v101
  v_fmac_f32 v5, v102, v102
  v_fmac_f32 v5, v103, v103
  v_mov_b32 v6, v5
  s_nop 1
  v_permlane32_swap_b32 v5, v6
  s_nop 1
  v_add_f32 v5, v5, v6
  s_nop 1
  v_max_f32_dpp v5, v5, v5 quad_perm:[1,0,3,2] row_mask:0xf bank_mask:0xf
  s_nop 1
  v_max_f32_dpp v5, v5, v5 quad_perm:[2,3,0,1] row_mask:0xf bank_mask:0xf
  s_nop 1
  v_max_f32_dpp v5, v5, v5 row_half_mirror row_mask:0xf bank_mask:0xf
  s_nop 1
  v_max_f32_dpp v5, v5, v5 row_mirror row_mask:0xf bank_mask:0xf
  s_nop 1
  v_readlane_b32 s68, v5, 0
  v_readlane_b32 s69, v5, 16
  s_nop 1
  v_mov_b32 v7, s68
  v_max_f32 v5, s69, v7
  s_lshl_b32 s67, s63, 7
  s_add_u32 s67, s67, s74
  s_lshl_b32 s67, s67, 2
  s_add_u32 s67, s67, 19939328
  v_mov_b32 v7, 0
  v_cmp_eq_u32 vcc, 0, v1
  s_and_saveexec_b64 s[70:71], vcc
  buffer_store_dword v4, v7, s[36:39], s67 offen
  buffer_store_dword v5, v7, s[36:39], s67 offen offset:256
  s_mov_b64 exec, s[70:71]
  k1_qkv_kernel_nokn1:
  s_cmp_eq_u32 s62, 0
  s_cbranch_scc0 k1_qkv_kernel_nosc1
  s_mov_b32 s80, 0x3eb8aa3b
  s_mov_b32 s81, 0x3eb8aa3b
  v_mul_f32 v88, s80, v88
  v_mul_f32 v89, s80, v89
  v_mul_f32 v90, s80, v90
  v_mul_f32 v91, s80, v91
  v_mul_f32 v92, s80, v92
  v_mul_f32 v93, s80, v93
  v_mul_f32 v94, s80, v94
  v_mul_f32 v95, s80, v95
  v_mul_f32 v96, s80, v96
  v_mul_f32 v97, s80, v97
  v_mul_f32 v98, s80, v98
  v_mul_f32 v99, s80, v99
  v_mul_f32 v100, s80, v100
  v_mul_f32 v101, s80, v101
  v_mul_f32 v102, s80, v102
  v_mul_f32 v103, s80, v103
  k1_qkv_kernel_nosc1:
  v_cvt_pk_bf16_f32 v88, v88, v89
  v_cvt_pk_bf16_f32 v89, v90, v91
  v_cvt_pk_bf16_f32 v90, v92, v93
  v_cvt_pk_bf16_f32 v91, v94, v95
  v_cvt_pk_bf16_f32 v92, v96, v97
  v_cvt_pk_bf16_f32 v93, v98, v99
  v_cvt_pk_bf16_f32 v94, v100, v101
  v_cvt_pk_bf16_f32 v95, v102, v103
  s_cmp_eq_u32 s62, 2
  s_cselect_b64 vcc, -1, 0
  v_cndmask_b32 v3, v14, v2, vcc
  buffer_store_dwordx4 v[88:91], v3, s[36:39], s65 offen sc1
  s_add_u32 s65, s65, 65536
  buffer_store_dwordx4 v[92:95], v3, s[36:39], s65 offen sc1
  s_nop 7
  s_nop 7
  s_mul_i32 s61, s52, 3
  s_add_u32 s61, s61, 2
  s_lshr_b32 s62, s61, 4
  s_and_b32 s63, s61, 15
  s_lshl_b32 s65, s62, 21
  s_lshl_b32 s66, s63, 7
  s_add_u32 s66, s66, s74
  s_lshl_b32 s66, s66, 10
  s_add_u32 s65, s65, s66
  s_cmp_eq_u32 s62, 1
  s_cbranch_scc0 k1_qkv_kernel_nokn2
  v_mul_f32 v4, v104, v104
  v_fmac_f32 v4, v105, v105
  v_fmac_f32 v4, v106, v106
  v_fmac_f32 v4, v107, v107
  v_fmac_f32 v4, v108, v108
  v_fmac_f32 v4, v109, v109
  v_fmac_f32 v4, v110, v110
  v_fmac_f32 v4, v111, v111
  v_mov_b32 v6, v4
  s_nop 1
  v_permlane32_swap_b32 v4, v6
  s_nop 1
  v_add_f32 v4, v4, v6
  s_nop 1
  v_max_f32_dpp v4, v4, v4 quad_perm:[1,0,3,2] row_mask:0xf bank_mask:0xf
  s_nop 1
  v_max_f32_dpp v4, v4, v4 quad_perm:[2,3,0,1] row_mask:0xf bank_mask:0xf
  s_nop 1
  v_max_f32_dpp v4, v4, v4 row_half_mirror row_mask:0xf bank_mask:0xf
  s_nop 1
  v_max_f32_dpp v4, v4, v4 row_mirror row_mask:0xf bank_mask:0xf
  s_nop 1
  v_readlane_b32 s68, v4, 0
  v_readlane_b32 s69, v4, 16
  s_nop 1
  v_mov_b32 v7, s68
  v_max_f32 v4, s69, v7
  v_mul_f32 v5, v112, v112
  v_fmac_f32 v5, v113, v113
  v_fmac_f32 v5, v114, v114
  v_fmac_f32 v5, v115, v115
  v_fmac_f32 v5, v116, v116
  v_fmac_f32 v5, v117, v117
  v_fmac_f32 v5, v118, v118
  v_fmac_f32 v5, v119, v119
  v_mov_b32 v6, v5
  s_nop 1
  v_permlane32_swap_b32 v5, v6
  s_nop 1
  v_add_f32 v5, v5, v6
  s_nop 1
  v_max_f32_dpp v5, v5, v5 quad_perm:[1,0,3,2] row_mask:0xf bank_mask:0xf
  s_nop 1
  v_max_f32_dpp v5, v5, v5 quad_perm:[2,3,0,1] row_mask:0xf bank_mask:0xf
  s_nop 1
  v_max_f32_dpp v5, v5, v5 row_half_mirror row_mask:0xf bank_mask:0xf
  s_nop 1
  v_max_f32_dpp v5, v5, v5 row_mirror row_mask:0xf bank_mask:0xf
  s_nop 1
  v_readlane_b32 s68, v5, 0
  v_readlane_b32 s69, v5, 16
  s_nop 1
  v_mov_b32 v7, s68
  v_max_f32 v5, s69, v7
  s_lshl_b32 s67, s63, 7
  s_add_u32 s67, s67, s74
  s_lshl_b32 s67, s67, 2
  s_add_u32 s67, s67, 19939328
  v_mov_b32 v7, 0
  v_cmp_eq_u32 vcc, 0, v1
  s_and_saveexec_b64 s[70:71], vcc
  buffer_store_dword v4, v7, s[36:39], s67 offen
  buffer_store_dword v5, v7, s[36:39], s67 offen offset:256
  s_mov_b64 exec, s[70:71]
  k1_qkv_kernel_nokn2:
  s_cmp_eq_u32 s62, 0
  s_cbranch_scc0 k1_qkv_kernel_nosc2
  s_mov_b32 s80, 0x3eb8aa3b
  s_mov_b32 s81, 0x3eb8aa3b
  v_mul_f32 v104, s80, v104
  v_mul_f32 v105, s80, v105
  v_mul_f32 v106, s80, v106
  v_mul_f32 v107, s80, v107
  v_mul_f32 v108, s80, v108
  v_mul_f32 v109, s80, v109
  v_mul_f32 v110, s80, v110
  v_mul_f32 v111, s80, v111
  v_mul_f32 v112, s80, v112
  v_mul_f32 v113, s80, v113
  v_mul_f32 v114, s80, v114
  v_mul_f32 v115, s80, v115
  v_mul_f32 v116, s80, v116
  v_mul_f32 v117, s80, v117
  v_mul_f32 v118, s80, v118
  v_mul_f32 v119, s80, v119
  k1_qkv_kernel_nosc2:
  v_cvt_pk_bf16_f32 v104, v104, v105
  v_cvt_pk_bf16_f32 v105, v106, v107
  v_cvt_pk_bf16_f32 v106, v108, v109
  v_cvt_pk_bf16_f32 v107, v110, v111
  v_cvt_pk_bf16_f32 v108, v112, v113
  v_cvt_pk_bf16_f32 v109, v114, v115
  v_cvt_pk_bf16_f32 v110, v116, v117
  v_cvt_pk_bf16_f32 v111, v118, v119
  s_cmp_eq_u32 s62, 2
  s_cselect_b64 vcc, -1, 0
  v_cndmask_b32 v3, v14, v2, vcc
  buffer_store_dwordx4 v[104:107], v3, s[36:39], s65 offen sc1
  s_add_u32 s65, s65, 65536
  buffer_store_dwordx4 v[108:111], v3, s[36:39], s65 offen sc1
  s_endpgm
k1_qkv_kernel_typeB:
  s_cmp_ge_u32 s52, 14
  s_cbranch_scc0 k1_qkv_kernel_typeB2
  s_barrier
  s_barrier
  s_barrier
  s_barrier
  s_barrier
  s_barrier
  s_barrier
  s_barrier
  s_endpgm
k1_qkv_kernel_typeB2:
  v_mov_b32 v64, 0
  v_mov_b32 v65, 0
  v_mov_b32 v66, 0
  v_mov_b32 v67, 0
  v_mov_b32 v68, 0
  v_mov_b32 v69, 0
  v_mov_b32 v70, 0
  v_mov_b32 v71, 0
  v_mov_b32 v72, 0
  v_mov_b32 v73, 0
  v_mov_b32 v74, 0
  v_mov_b32 v75, 0
  v_mov_b32 v76, 0
  v_mov_b32 v77, 0
  v_mov_b32 v78, 0
  v_mov_b32 v79, 0
  v_mov_b32 v80, 0
  v_mov_b32 v81, 0
  v_mov_b32 v82, 0
  v_mov_b32 v83, 0
  v_mov_b32 v84, 0
  v_mov_b32 v85, 0
  v_mov_b32 v86, 0
  v_mov_b32 v87, 0
  v_mov_b32 v88, 0
  v_mov_b32 v89, 0
  v_mov_b32 v90, 0
  v_mov_b32 v91, 0
  v_mov_b32 v92, 0
  v_mov_b32 v93, 0
  v_mov_b32 v94, 0
  v_mov_b32 v95, 0
  v_mov_b32 v96, 0
  v_mov_b32 v97, 0
  v_mov_b32 v98, 0
  v_mov_b32 v99, 0
  v_mov_b32 v100, 0
  v_mov_b32 v101, 0
  v_mov_b32 v102, 0
  v_mov_b32 v103, 0
  v_mov_b32 v104, 0
  v_mov_b32 v105, 0
  v_mov_b32 v106, 0
  v_mov_b32 v107, 0
  v_mov_b32 v108, 0
  v_mov_b32 v109, 0
  v_mov_b32 v110, 0
  v_mov_b32 v111, 0
  v_mov_b32 v112, 0
  v_mov_b32 v113, 0
  v_mov_b32 v114, 0
  v_mov_b32 v115, 0
  v_mov_b32 v116, 0
  v_mov_b32 v117, 0
  v_mov_b32 v118, 0
  v_mov_b32 v119, 0
  v_mov_b32 v120, 0
  v_mov_b32 v121, 0
  v_mov_b32 v122, 0
  v_mov_b32 v123, 0
  v_mov_b32 v124, 0
  v_mov_b32 v125, 0
  v_mov_b32 v126, 0
  v_mov_b32 v127, 0
  s_waitcnt lgkmcnt(0)
  s_barrier
  ds_read_b128 v[16:19], v8
  ds_read_b64_tr_b16 v[32:33], v12 offset:12352
  ds_read_b64_tr_b16 v[34:35], v12 offset:13120
  ds_read_b64_tr_b16 v[36:37], v12 offset:24640
  ds_read_b64_tr_b16 v[38:39], v12 offset:25408
  ds_read_b64_tr_b16 v[40:41], v12 offset:12416
  ds_read_b64_tr_b16 v[42:43], v12 offset:13184
  ds_read_b64_tr_b16 v[44:45], v12 offset:24704
  ds_read_b64_tr_b16 v[46:47], v12 offset:25472
  .p2align 6
k1_qkv_kernel_loopB:
  s_waitcnt lgkmcnt(6)
  v_mfma_f32_32x32x16_bf16 v[64:79], v[32:35], v[16:19], v[64:79]
  ds_read_b128 v[20:23], v9
  ds_read_b64_tr_b16 v[48:49], v12 offset:15424
  ds_read_b64_tr_b16 v[50:51], v12 offset:16192
  s_waitcnt lgkmcnt(7)
  v_mfma_f32_32x32x16_bf16 v[80:95], v[36:39], v[16:19], v[80:95]
  ds_read_b64_tr_b16 v[52:53], v12 offset:27712
  ds_read_b64_tr_b16 v[54:55], v12 offset:28480
  ds_read_b64_tr_b16 v[56:57], v12 offset:15488
  s_waitcnt lgkmcnt(8)
  v_mfma_f32_32x32x16_bf16 v[96:111], v[40:43], v[16:19], v[96:111]
  ds_read_b64_tr_b16 v[58:59], v12 offset:16256
  ds_read_b64_tr_b16 v[60:61], v12 offset:27776
  ds_read_b64_tr_b16 v[62:63], v12 offset:28544
  s_waitcnt lgkmcnt(9)
  v_mfma_f32_32x32x16_bf16 v[112:127], v[44:47], v[16:19], v[112:127]
  s_waitcnt lgkmcnt(6)
  v_mfma_f32_32x32x16_bf16 v[64:79], v[48:51], v[20:23], v[64:79]
  ds_read_b128 v[16:19], v10
  ds_read_b64_tr_b16 v[32:33], v12 offset:18496
  ds_read_b64_tr_b16 v[34:35], v12 offset:19264
  s_waitcnt lgkmcnt(7)
  v_mfma_f32_32x32x16_bf16 v[80:95], v[52:55], v[20:23], v[80:95]
  ds_read_b64_tr_b16 v[36:37], v12 offset:30784
  ds_read_b64_tr_b16 v[38:39], v12 offset:31552
  ds_read_b64_tr_b16 v[40:41], v12 offset:18560
  s_waitcnt lgkmcnt(8)
  v_mfma_f32_32x32x16_bf16 v[96:111], v[56:59], v[20:23], v[96:111]
  ds_read_b64_tr_b16 v[42:43], v12 offset:19328
  ds_read_b64_tr_b16 v[44:45], v12 offset:30848
  ds_read_b64_tr_b16 v[46:47], v12 offset:31616
  s_waitcnt lgkmcnt(9)
  v_mfma_f32_32x32x16_bf16 v[112:127], v[60:63], v[20:23], v[112:127]
  s_waitcnt lgkmcnt(6)
  v_mfma_f32_32x32x16_bf16 v[64:79], v[32:35], v[16:19], v[64:79]
  ds_read_b128 v[20:23], v11
  ds_read_b64_tr_b16 v[48:49], v12 offset:21568
  ds_read_b64_tr_b16 v[50:51], v12 offset:22336
  s_waitcnt lgkmcnt(7)
  v_mfma_f32_32x32x16_bf16 v[80:95], v[36:39], v[16:19], v[80:95]
  ds_read_b64_tr_b16 v[52:53], v12 offset:33856
  ds_read_b64_tr_b16 v[54:55], v12 offset:34624
  ds_read_b64_tr_b16 v[56:57], v12 offset:21632
  s_waitcnt lgkmcnt(8)
  v_mfma_f32_32x32x16_bf16 v[96:111], v[40:43], v[16:19], v[96:111]
  ds_read_b64_tr_b16 v[58:59], v12 offset:22400
  ds_read_b64_tr_b16 v[60:61], v12 offset:33920
  ds_read_b64_tr_b16 v[62:63], v12 offset:34688
  s_waitcnt lgkmcnt(9)
  v_mfma_f32_32x32x16_bf16 v[112:127], v[44:47], v[16:19], v[112:127]
  s_waitcnt lgkmcnt(0)
  v_mfma_f32_32x32x16_bf16 v[64:79], v[48:51], v[20:23], v[64:79]
  s_barrier
  s_add_u32 s61, s61, 1
  s_cmp_eq_u32 s61, 3
  s_cselect_b32 s62, s72, s73
  s_cselect_b32 s61, 0, s61
  v_add_u32 v8, s62, v8
  v_add_u32 v9, s62, v9
  v_add_u32 v10, s62, v10
  v_add_u32 v11, s62, v11
  v_add_u32 v12, s62, v12
  ds_read_b128 v[16:19], v8
  ds_read_b64_tr_b16 v[32:33], v12 offset:12352
  ds_read_b64_tr_b16 v[34:35], v12 offset:13120
  v_mfma_f32_32x32x16_bf16 v[80:95], v[52:55], v[20:23], v[80:95]
  ds_read_b64_tr_b16 v[36:37], v12 offset:24640
  ds_read_b64_tr_b16 v[38:39], v12 offset:25408
  ds_read_b64_tr_b16 v[40:41], v12 offset:12416
  v_mfma_f32_32x32x16_bf16 v[96:111], v[56:59], v[20:23], v[96:111]
  ds_read_b64_tr_b16 v[42:43], v12 offset:13184
  ds_read_b64_tr_b16 v[44:45], v12 offset:24704
  ds_read_b64_tr_b16 v[46:47], v12 offset:25472
  v_mfma_f32_32x32x16_bf16 v[112:127], v[60:63], v[20:23], v[112:127]
  s_add_u32 s60, s60, 1
  s_cmp_lt_u32 s60, 6
  s_cbranch_scc1 k1_qkv_kernel_loopB
  v_add_u32 v13, 53248, v12
  s_waitcnt lgkmcnt(6)
  v_mfma_f32_32x32x16_bf16 v[64:79], v[32:35], v[16:19], v[64:79]
  ds_read_b128 v[20:23], v9
  ds_read_b128 v[24:27], v10
  ds_read_b128 v[28:31], v11
  ds_read_b64_tr_b16 v[48:49], v12 offset:15424
  s_waitcnt lgkmcnt(8)
  v_mfma_f32_32x32x16_bf16 v[80:95], v[36:39], v[16:19], v[80:95]
  ds_read_b64_tr_b16 v[50:51], v12 offset:16192
  ds_read_b64_tr_b16 v[52:53], v12 offset:27712
  ds_read_b64_tr_b16 v[54:55], v12 offset:28480
  ds_read_b64_tr_b16 v[56:57], v12 offset:18496
  s_waitcnt lgkmcnt(10)
  v_mfma_f32_32x32x16_bf16 v[96:111], v[40:43], v[16:19], v[96:111]
  ds_read_b64_tr_b16 v[58:59], v12 offset:19264
  ds_read_b64_tr_b16 v[60:61], v12 offset:30784
  ds_read_b64_tr_b16 v[62:63], v12 offset:31552
  s_waitcnt lgkmcnt(11)
  v_mfma_f32_32x32x16_bf16 v[112:127], v[44:47], v[16:19], v[112:127]
  s_mov_b32 s36, s24
  s_and_b32 s37, s25, 0xffff
  s_mov_b32 s38, 33554432
  s_mov_b32 s39, 0x00020000
  s_mov_b32 s76, 0xbfb8aa3b
  s_mov_b32 s77, 0xbfb8aa3b
  s_mov_b32 s78, 1.0
  s_mov_b32 s79, 1.0
  s_add_u32 s58, s74, 0
  s_mul_i32 s58, s74, 118
  s_add_u32 s58, s58, 32
  s_waitcnt lgkmcnt(6)
  v_mfma_f32_32x32x16_bf16 v[64:79], v[48:51], v[20:23], v[64:79]
  ds_read_b64_tr_b16 v[32:33], v12 offset:21568
  ds_read_b64_tr_b16 v[34:35], v12 offset:22336
  s_waitcnt lgkmcnt(6)
  v_mfma_f32_32x32x16_bf16 v[80:95], v[52:55], v[20:23], v[80:95]
  ds_read_b64_tr_b16 v[36:37], v12 offset:33856
  ds_read_b64_tr_b16 v[38:39], v12 offset:34624
  s_waitcnt lgkmcnt(6)
  v_mfma_f32_32x32x16_bf16 v[64:79], v[56:59], v[24:27], v[64:79]
  s_waitcnt lgkmcnt(4)
  v_mfma_f32_32x32x16_bf16 v[80:95], v[60:63], v[24:27], v[80:95]
  s_barrier
  v_add_u32 v8, 53248, v8
  v_add_u32 v9, 53248, v9
  v_add_u32 v10, 53248, v10
  v_add_u32 v11, 53248, v11
  ds_read_b128 v[16:19], v8
  ds_read_b128 v[152:155], v9
  ds_read_b128 v[156:159], v10
  ds_read_b128 v[160:163], v11
  ds_read_b64_tr_b16 v[40:41], v13 offset:12352
  ds_read_b64_tr_b16 v[42:43], v13 offset:13120
  ds_read_b64_tr_b16 v[44:45], v13 offset:24640
  ds_read_b64_tr_b16 v[46:47], v13 offset:25408
  s_waitcnt lgkmcnt(10)
  v_mfma_f32_32x32x16_bf16 v[64:79], v[32:35], v[28:31], v[64:79]
  ds_read_b64_tr_b16 v[48:49], v13 offset:15424
  ds_read_b64_tr_b16 v[50:51], v13 offset:16192
  s_waitcnt lgkmcnt(10)
  v_mfma_f32_32x32x16_bf16 v[80:95], v[36:39], v[28:31], v[80:95]
  ds_read_b64_tr_b16 v[52:53], v13 offset:27712
  ds_read_b64_tr_b16 v[54:55], v13 offset:28480
  s_waitcnt lgkmcnt(6)
  v_mfma_f32_32x32x16_bf16 v[64:79], v[40:43], v[16:19], v[64:79]
  ds_read_b64_tr_b16 v[56:57], v13 offset:18496
  ds_read_b64_tr_b16 v[58:59], v13 offset:19264
  s_waitcnt lgkmcnt(6)
  v_mfma_f32_32x32x16_bf16 v[80:95], v[44:47], v[16:19], v[80:95]
  ds_read_b64_tr_b16 v[60:61], v13 offset:30784
  ds_read_b64_tr_b16 v[62:63], v13 offset:31552
  s_waitcnt lgkmcnt(6)
  v_mfma_f32_32x32x16_bf16 v[64:79], v[48:51], v[152:155], v[64:79]
  ds_read_b64_tr_b16 v[32:33], v13 offset:21568
  ds_read_b64_tr_b16 v[34:35], v13 offset:22336
  s_waitcnt lgkmcnt(6)
  v_mfma_f32_32x32x16_bf16 v[80:95], v[52:55], v[152:155], v[80:95]
  ds_read_b64_tr_b16 v[36:37], v13 offset:33856
  ds_read_b64_tr_b16 v[38:39], v13 offset:34624
  s_waitcnt lgkmcnt(6)
  v_mfma_f32_32x32x16_bf16 v[64:79], v[56:59], v[156:159], v[64:79]
  ds_read_b64_tr_b16 v[40:41], v12 offset:15488
  ds_read_b64_tr_b16 v[42:43], v12 offset:16256
  s_waitcnt lgkmcnt(6)
  v_mfma_f32_32x32x16_bf16 v[80:95], v[60:63], v[156:159], v[80:95]
  ds_read_b64_tr_b16 v[44:45], v12 offset:27776
  ds_read_b64_tr_b16 v[46:47], v12 offset:28544
  s_waitcnt lgkmcnt(6)
  v_mfma_f32_32x32x16_bf16 v[64:79], v[32:35], v[160:163], v[64:79]
  ds_read_b64_tr_b16 v[48:49], v12 offset:18560
  ds_read_b64_tr_b16 v[50:51], v12 offset:19328
  s_waitcnt lgkmcnt(6)
  v_mfma_f32_32x32x16_bf16 v[80:95], v[36:39], v[160:163], v[80:95]
  ds_read_b64_tr_b16 v[52:53], v12 offset:30848
  ds_read_b64_tr_b16 v[54:55], v12 offset:31616
  s_waitcnt lgkmcnt(6)
  v_mfma_f32_32x32x16_bf16 v[96:111], v[40:43], v[20:23], v[96:111]
  ds_read_b64_tr_b16 v[56:57], v12 offset:21632
  ds_read_b64_tr_b16 v[58:59], v12 offset:22400
  s_waitcnt lgkmcnt(6)
  v_mfma_f32_32x32x16_bf16 v[112:127], v[44:47], v[20:23], v[112:127]
  ds_read_b64_tr_b16 v[60:61], v12 offset:33920
  ds_read_b64_tr_b16 v[62:63], v12 offset:34688
  s_waitcnt lgkmcnt(6)
  v_mfma_f32_32x32x16_bf16 v[96:111], v[48:51], v[24:27], v[96:111]
  ds_read_b64_tr_b16 v[32:33], v13 offset:12416
  ds_read_b64_tr_b16 v[34:35], v13 offset:13184
  v_mul_f32 v4, s76, v64
  v_mul_f32 v5, s76, v65
  v_mul_f32 v6, s76, v66
  v_mul_f32 v7, s76, v67
  v_exp_f32 v4, v4
  s_waitcnt lgkmcnt(6)
  v_mfma_f32_32x32x16_bf16 v[112:127], v[52:55], v[24:27], v[112:127]
  ds_read_b64_tr_b16 v[36:37], v13 offset:24704
  ds_read_b64_tr_b16 v[38:39], v13 offset:25472
  v_exp_f32 v5, v5
  v_exp_f32 v6, v6
  v_exp_f32 v7, v7
  v_mul_f32 v64, v64, v80
  v_mul_f32 v65, v65, v81
  s_waitcnt lgkmcnt(6)
  v_mfma_f32_32x32x16_bf16 v[96:111], v[56:59], v[28:31], v[96:111]
  ds_read_b64_tr_b16 v[40:41], v13 offset:15488
  ds_read_b64_tr_b16 v[42:43], v13 offset:16256
  v_mul_f32 v66, v66, v82
  v_mul_f32 v67, v67, v83
  v_add_f32 v4, 1.0, v4
  v_add_f32 v5, 1.0, v5
  v_add_f32 v6, 1.0, v6
  s_waitcnt lgkmcnt(6)
  v_mfma_f32_32x32x16_bf16 v[112:127], v[60:63], v[28:31], v[112:127]
  ds_read_b64_tr_b16 v[44:45], v13 offset:27776
  ds_read_b64_tr_b16 v[46:47], v13 offset:28544
  v_add_f32 v7, 1.0, v7
  v_rcp_f32 v4, v4
  v_rcp_f32 v5, v5
  v_rcp_f32 v6, v6
  v_rcp_f32 v7, v7
  s_waitcnt lgkmcnt(6)
  v_mfma_f32_32x32x16_bf16 v[96:111], v[32:35], v[16:19], v[96:111]
  ds_read_b64_tr_b16 v[48:49], v13 offset:18560
  ds_read_b64_tr_b16 v[50:51], v13 offset:19328
  s_nop 0
  v_mul_f32 v64, v64, v4
  v_mul_f32 v65, v65, v5
  v_mul_f32 v66, v66, v6
  v_mul_f32 v67, v67, v7
  s_waitcnt lgkmcnt(6)
  v_mfma_f32_32x32x16_bf16 v[112:127], v[36:39], v[16:19], v[112:127]
  ds_read_b64_tr_b16 v[52:53], v13 offset:30848
  ds_read_b64_tr_b16 v[54:55], v13 offset:31616
  v_cvt_pk_bf16_f32 v80, v64, v65
  v_cvt_pk_bf16_f32 v81, v66, v67
  v_mul_f32 v4, s76, v68
  v_mul_f32 v5, s76, v69
  v_mul_f32 v6, s76, v70
  s_waitcnt lgkmcnt(6)
  v_mfma_f32_32x32x16_bf16 v[96:111], v[40:43], v[152:155], v[96:111]
  ds_read_b64_tr_b16 v[56:57], v13 offset:21632
  ds_read_b64_tr_b16 v[58:59], v13 offset:22400
  v_mul_f32 v7, s76, v71
  v_exp_f32 v4, v4
  v_exp_f32 v5, v5
  v_exp_f32 v6, v6
  v_exp_f32 v7, v7
  s_waitcnt lgkmcnt(6)
  v_mfma_f32_32x32x16_bf16 v[112:127], v[44:47], v[152:155], v[112:127]
  ds_read_b64_tr_b16 v[60:61], v13 offset:33920
  ds_read_b64_tr_b16 v[62:63], v13 offset:34688
  v_mul_f32 v68, v68, v84
  v_mul_f32 v69, v69, v85
  v_mul_f32 v70, v70, v86
  v_mul_f32 v71, v71, v87
  v_add_f32 v4, 1.0, v4
  s_waitcnt lgkmcnt(6)
  v_mfma_f32_32x32x16_bf16 v[96:111], v[48:51], v[156:159], v[96:111]
  v_add_f32 v5, 1.0, v5
  v_add_f32 v6, 1.0, v6
  v_add_f32 v7, 1.0, v7
  v_rcp_f32 v4, v4
  v_rcp_f32 v5, v5
  s_waitcnt lgkmcnt(4)
  v_mfma_f32_32x32x16_bf16 v[112:127], v[52:55], v[156:159], v[112:127]
  v_rcp_f32 v6, v6
  v_rcp_f32 v7, v7
  s_nop 0
  v_mul_f32 v68, v68, v4
  v_mul_f32 v69, v69, v5
  s_waitcnt lgkmcnt(2)
  v_mfma_f32_32x32x16_bf16 v[96:111], v[56:59], v[160:163], v[96:111]
  v_mul_f32 v70, v70, v6
  v_mul_f32 v71, v71, v7
  v_cvt_pk_bf16_f32 v82, v68, v69
  v_cvt_pk_bf16_f32 v83, v70, v71
  v_mul_f32 v4, s76, v72
  s_waitcnt lgkmcnt(0)
  v_mfma_f32_32x32x16_bf16 v[112:127], v[60:63], v[160:163], v[112:127]
  v_mul_f32 v5, s76, v73
  v_mul_f32 v6, s76, v74
  v_mul_f32 v7, s76, v75
  v_exp_f32 v4, v4
  v_exp_f32 v5, v5
  s_nop 7
  s_nop 7
  v_exp_f32 v6, v6
  v_exp_f32 v7, v7
  v_mul_f32 v72, v72, v88
  v_mul_f32 v73, v73, v89
  v_mul_f32 v74, v74, v90
  v_mul_f32 v75, v75, v91
  v_add_f32 v4, 1.0, v4
  v_add_f32 v5, 1.0, v5
  v_add_f32 v6, 1.0, v6
  v_add_f32 v7, 1.0, v7
  v_rcp_f32 v4, v4
  v_rcp_f32 v5, v5
  v_rcp_f32 v6, v6
  v_rcp_f32 v7, v7
  s_nop 0
  v_mul_f32 v72, v72, v4
  v_mul_f32 v73, v73, v5
  v_mul_f32 v74, v74, v6
  v_mul_f32 v75, v75, v7
  v_cvt_pk_bf16_f32 v84, v72, v73
  v_cvt_pk_bf16_f32 v85, v74, v75
  v_mul_f32 v4, s76, v76
  v_mul_f32 v5, s76, v77
  v_mul_f32 v6, s76, v78
  v_mul_f32 v7, s76, v79
  v_exp_f32 v4, v4
  v_exp_f32 v5, v5
  v_exp_f32 v6, v6
  v_exp_f32 v7, v7
  v_mul_f32 v76, v76, v92
  v_mul_f32 v77, v77, v93
  v_mul_f32 v78, v78, v94
  v_mul_f32 v79, v79, v95
  v_add_f32 v4, 1.0, v4
  v_add_f32 v5, 1.0, v5
  v_add_f32 v6, 1.0, v6
  v_add_f32 v7, 1.0, v7
  v_rcp_f32 v4, v4
  v_rcp_f32 v5, v5
  v_rcp_f32 v6, v6
  v_rcp_f32 v7, v7
  s_nop 0
  v_mul_f32 v76, v76, v4
  v_mul_f32 v77, v77, v5
  v_mul_f32 v78, v78, v6
  v_mul_f32 v79, v79, v7
  v_cvt_pk_bf16_f32 v86, v76, v77
  v_cvt_pk_bf16_f32 v87, v78, v79
  s_mul_i32 s61, s52, 3
  s_add_u32 s61, s61, 1
  s_lshl_b32 s62, s61, 1
  s_add_u32 s62, s62, s58
  s_lshl_b32 s62, s62, 10
  s_add_u32 s62, s62, 6291456
  s_cmp_ge_u32 s61, 43
  s_cbranch_scc1 k1_qkv_kernel_sk1
  buffer_store_dwordx4 v[80:83], v14, s[36:39], s62 offen sc1
  buffer_store_dwordx4 v[84:87], v14, s[36:39], s62 offen offset:1024 sc1
  k1_qkv_kernel_sk1:
  v_mul_f32 v4, s76, v96
  v_mul_f32 v5, s76, v97
  v_mul_f32 v6, s76, v98
  v_mul_f32 v7, s76, v99
  v_exp_f32 v4, v4
  v_exp_f32 v5, v5
  v_exp_f32 v6, v6
  v_exp_f32 v7, v7
  v_mul_f32 v96, v96, v112
  v_mul_f32 v97, v97, v113
  v_mul_f32 v98, v98, v114
  v_mul_f32 v99, v99, v115
  v_add_f32 v4, 1.0, v4
  v_add_f32 v5, 1.0, v5
  v_add_f32 v6, 1.0, v6
  v_add_f32 v7, 1.0, v7
  v_rcp_f32 v4, v4
  v_rcp_f32 v5, v5
  v_rcp_f32 v6, v6
  v_rcp_f32 v7, v7
  s_nop 0
  v_mul_f32 v96, v96, v4
  v_mul_f32 v97, v97, v5
  v_mul_f32 v98, v98, v6
  v_mul_f32 v99, v99, v7
  v_cvt_pk_bf16_f32 v112, v96, v97
  v_cvt_pk_bf16_f32 v113, v98, v99
  v_mul_f32 v4, s76, v100
  v_mul_f32 v5, s76, v101
  v_mul_f32 v6, s76, v102
  v_mul_f32 v7, s76, v103
  v_exp_f32 v4, v4
  v_exp_f32 v5, v5
  v_exp_f32 v6, v6
  v_exp_f32 v7, v7
  v_mul_f32 v100, v100, v116
  v_mul_f32 v101, v101, v117
  v_mul_f32 v102, v102, v118
  v_mul_f32 v103, v103, v119
  v_add_f32 v4, 1.0, v4
  v_add_f32 v5, 1.0, v5
  v_add_f32 v6, 1.0, v6
  v_add_f32 v7, 1.0, v7
  v_rcp_f32 v4, v4
  v_rcp_f32 v5, v5
  v_rcp_f32 v6, v6
  v_rcp_f32 v7, v7
  s_nop 0
  v_mul_f32 v100, v100, v4
  v_mul_f32 v101, v101, v5
  v_mul_f32 v102, v102, v6
  v_mul_f32 v103, v103, v7
  v_cvt_pk_bf16_f32 v114, v100, v101
  v_cvt_pk_bf16_f32 v115, v102, v103
  v_mul_f32 v4, s76, v104
  v_mul_f32 v5, s76, v105
  v_mul_f32 v6, s76, v106
  v_mul_f32 v7, s76, v107
  v_exp_f32 v4, v4
  v_exp_f32 v5, v5
  v_exp_f32 v6, v6
  v_exp_f32 v7, v7
  v_mul_f32 v104, v104, v120
  v_mul_f32 v105, v105, v121
  v_mul_f32 v106, v106, v122
  v_mul_f32 v107, v107, v123
  v_add_f32 v4, 1.0, v4
  v_add_f32 v5, 1.0, v5
  v_add_f32 v6, 1.0, v6
  v_add_f32 v7, 1.0, v7
  v_rcp_f32 v4, v4
  v_rcp_f32 v5, v5
  v_rcp_f32 v6, v6
  v_rcp_f32 v7, v7
  s_nop 0
  v_mul_f32 v104, v104, v4
  v_mul_f32 v105, v105, v5
  v_mul_f32 v106, v106, v6
  v_mul_f32 v107, v107, v7
  v_cvt_pk_bf16_f32 v116, v104, v105
  v_cvt_pk_bf16_f32 v117, v106, v107
  v_mul_f32 v4, s76, v108
  v_mul_f32 v5, s76, v109
  v_mul_f32 v6, s76, v110
  v_mul_f32 v7, s76, v111
  v_exp_f32 v4, v4
  v_exp_f32 v5, v5
  v_exp_f32 v6, v6
  v_exp_f32 v7, v7
  v_mul_f32 v108, v108, v124
  v_mul_f32 v109, v109, v125
  v_mul_f32 v110, v110, v126
  v_mul_f32 v111, v111, v127
  v_add_f32 v4, 1.0, v4
  v_add_f32 v5, 1.0, v5
  v_add_f32 v6, 1.0, v6
  v_add_f32 v7, 1.0, v7
  v_rcp_f32 v4, v4
  v_rcp_f32 v5, v5
  v_rcp_f32 v6, v6
  v_rcp_f32 v7, v7
  s_nop 0
  v_mul_f32 v108, v108, v4
  v_mul_f32 v109, v109, v5
  v_mul_f32 v110, v110, v6
  v_mul_f32 v111, v111, v7
  v_cvt_pk_bf16_f32 v118, v108, v109
  v_cvt_pk_bf16_f32 v119, v110, v111
  s_mul_i32 s61, s52, 3
  s_add_u32 s61, s61, 2
  s_lshl_b32 s62, s61, 1
  s_add_u32 s62, s62, s58
  s_lshl_b32 s62, s62, 10
  s_add_u32 s62, s62, 6291456
  s_cmp_ge_u32 s61, 43
  s_cbranch_scc1 k1_qkv_kernel_sk2
  buffer_store_dwordx4 v[112:115], v14, s[36:39], s62 offen sc1
  buffer_store_dwordx4 v[116:119], v14, s[36:39], s62 offen offset:1024 sc1
  k1_qkv_kernel_sk2:
  s_endpgm
k1_qkv_kernel_loader:
  s_setprio 2
  s_mov_b32 s49, s48
  v_lshrrev_b32 v5, 3, v1
  v_lshlrev_b32 v5, 10, v5
  v_and_b32 v6, 7, v1
  v_lshrrev_b32 v7, 4, v1
  v_xor_b32 v6, v6, v7
  v_lshl_add_u32 v3, v6, 4, v5
  v_xor_b32 v4, 64, v3
  s_mul_i32 s53, s49, 192
  s_cmp_eq_u32 s52, 14
  s_cselect_b32 s54, 0x40000000, 0
  v_mov_b32 v15, s54
  v_add_u32 v11, s53, v1
  v_add_u32 v11, 0, v11
  v_mul_u32_u24 v12, 0x1556, v11
  v_lshrrev_b32 v12, 16, v12
  v_mul_u32_u24 v13, 12, v12
  v_sub_u32 v13, v11, v13
  v_lshlrev_b32 v13, 4, v13
  v_mul_u32_u24 v11, 0xc00, v12
  v_add_u32 v5, v11, v13
  v_mul_u32_u24 v11, 0xac0, v12
  v_add_u32 v8, v11, v13
  v_cmp_le_u32 vcc, 64, v13
  s_nop 1
  v_cndmask_b32 v16, 0, v15, vcc
  v_add_u32 v8, v8, v16
  v_add_u32 v11, s53, v1
  v_add_u32 v11, 64, v11
  v_mul_u32_u24 v12, 0x1556, v11
  v_lshrrev_b32 v12, 16, v12
  v_mul_u32_u24 v13, 12, v12
  v_sub_u32 v13, v11, v13
  v_lshlrev_b32 v13, 4, v13
  v_mul_u32_u24 v11, 0xc00, v12
  v_add_u32 v6, v11, v13
  v_mul_u32_u24 v11, 0xac0, v12
  v_add_u32 v9, v11, v13
  v_cmp_le_u32 vcc, 64, v13
  s_nop 1
  v_cndmask_b32 v16, 0, v15, vcc
  v_add_u32 v9, v9, v16
  v_add_u32 v11, s53, v1
  v_add_u32 v11, 128, v11
  v_mul_u32_u24 v12, 0x1556, v11
  v_lshrrev_b32 v12, 16, v12
  v_mul_u32_u24 v13, 12, v12
  v_sub_u32 v13, v11, v13
  v_lshlrev_b32 v13, 4, v13
  v_mul_u32_u24 v11, 0xc00, v12
  v_add_u32 v7, v11, v13
  v_mul_u32_u24 v11, 0xac0, v12
  v_add_u32 v10, v11, v13
  v_cmp_le_u32 vcc, 64, v13
  s_nop 1
  v_cndmask_b32 v16, 0, v15, vcc
  v_add_u32 v10, v10, v16
  s_lshl_b32 s56, s51, 7
  s_lshl_b32 s57, s49, 5
  s_add_u32 s56, s56, s57
  s_lshl_b32 s56, s56, 10
  s_mul_i32 s57, s52, 192
  s_lshl_b32 s58, s49, 12
  s_mul_i32 s59, s49, 3072
  s_waitcnt lgkmcnt(0)
  s_mov_b32 s28, s4
  s_and_b32 s29, s5, 0xffff
  s_mov_b32 s30, 2097152
  s_mov_b32 s31, 0x00020000
  s_mov_b32 s32, s6
  s_and_b32 s33, s7, 0xffff
  s_mov_b32 s34, 1572864
  s_mov_b32 s35, 0x00020000
  s_mov_b32 s40, s12
  s_and_b32 s41, s13, 0xffff
  s_mov_b32 s42, 1409024
  s_mov_b32 s43, 0x00020000
  s_mov_b32 s44, s14
  s_and_b32 s45, s15, 0xffff
  s_mov_b32 s46, 1409024
  s_mov_b32 s47, 0x00020000
  s_cmp_eq_u32 s52, 15
  s_cselect_b32 s42, 0, s42
  s_cselect_b32 s46, 0, s46
  s_mov_b32 s36, s24
  s_and_b32 s37, s25, 0xffff
  s_mov_b32 s38, 33554432
  s_mov_b32 s39, 0x00020000
  s_lshr_b32 s85, s2, 3
  s_lshr_b32 s86, s85, 3
  s_and_b32 s84, s85, 1
  s_xor_b32 s85, s84, 0
  s_lshl_b32 s86, s85, 7
  s_add_u32 s86, s86, s56
  s_add_u32 m0, s58, 0
  s_add_u32 s60, s86, 0
  buffer_load_dwordx4 v3, s[28:31], s60 offen lds
  s_add_u32 m0, s58, 1024
  s_add_u32 s60, s86, 8192
  buffer_load_dwordx4 v4, s[28:31], s60 offen lds
  s_add_u32 m0, s58, 2048
  s_add_u32 s60, s86, 16384
  buffer_load_dwordx4 v3, s[28:31], s60 offen lds
  s_add_u32 m0, s58, 3072
  s_add_u32 s60, s86, 24576
  buffer_load_dwordx4 v4, s[28:31], s60 offen lds
  s_mul_i32 s86, s85, 196608
  s_add_u32 s86, s86, s57
  s_add_u32 m0, s59, 16384
  s_nop 0
  buffer_load_dwordx4 v5, s[32:35], s86 offen lds
  s_add_u32 m0, s59, 17408
  s_nop 0
  buffer_load_dwordx4 v6, s[32:35], s86 offen lds
  s_add_u32 m0, s59, 18432
  s_nop 0
  buffer_load_dwordx4 v7, s[32:35], s86 offen lds
  s_mul_i32 s86, s85, 176128
  s_add_u32 s86, s86, s57
  s_add_u32 m0, s59, 28672
  s_nop 0
  buffer_load_dwordx4 v8, s[40:43], s86 offen lds
  s_add_u32 m0, s59, 29696
  s_nop 0
  buffer_load_dwordx4 v9, s[40:43], s86 offen lds
  s_add_u32 m0, s59, 30720
  s_nop 0
  buffer_load_dwordx4 v10, s[40:43], s86 offen lds
  s_add_u32 m0, s59, 40960
  s_nop 0
  buffer_load_dwordx4 v8, s[44:47], s86 offen lds
  s_add_u32 m0, s59, 41984
  s_nop 0
  buffer_load_dwordx4 v9, s[44:47], s86 offen lds
  s_add_u32 m0, s59, 43008
  s_nop 0
  buffer_load_dwordx4 v10, s[44:47], s86 offen lds
  s_waitcnt vmcnt(4)
  s_xor_b32 s85, s84, 1
  s_lshl_b32 s86, s85, 7
  s_add_u32 s86, s86, s56
  s_add_u32 m0, s58, 53248
  s_add_u32 s60, s86, 0
  buffer_load_dwordx4 v3, s[28:31], s60 offen lds
  s_add_u32 m0, s58, 54272
  s_add_u32 s60, s86, 8192
  buffer_load_dwordx4 v4, s[28:31], s60 offen lds
  s_add_u32 m0, s58, 55296
  s_add_u32 s60, s86, 16384
  buffer_load_dwordx4 v3, s[28:31], s60 offen lds
  s_add_u32 m0, s58, 56320
  s_add_u32 s60, s86, 24576
  buffer_load_dwordx4 v4, s[28:31], s60 offen lds
  s_mul_i32 s86, s85, 196608
  s_add_u32 s86, s86, s57
  s_add_u32 m0, s59, 69632
  s_nop 0
  buffer_load_dwordx4 v5, s[32:35], s86 offen lds
  s_add_u32 m0, s59, 70656
  s_nop 0
  buffer_load_dwordx4 v6, s[32:35], s86 offen lds
  s_add_u32 m0, s59, 71680
  s_nop 0
  buffer_load_dwordx4 v7, s[32:35], s86 offen lds
  s_mul_i32 s86, s85, 176128
  s_add_u32 s86, s86, s57
  s_add_u32 m0, s59, 81920
  s_nop 0
  buffer_load_dwordx4 v8, s[40:43], s86 offen lds
  s_add_u32 m0, s59, 82944
  s_nop 0
  buffer_load_dwordx4 v9, s[40:43], s86 offen lds
  s_add_u32 m0, s59, 83968
  s_nop 0
  buffer_load_dwordx4 v10, s[40:43], s86 offen lds
  s_add_u32 m0, s59, 94208
  s_nop 0
  buffer_load_dwordx4 v8, s[44:47], s86 offen lds
  s_add_u32 m0, s59, 95232
  s_nop 0
  buffer_load_dwordx4 v9, s[44:47], s86 offen lds
  s_add_u32 m0, s59, 96256
  s_nop 0
  buffer_load_dwordx4 v10, s[44:47], s86 offen lds
  s_waitcnt vmcnt(13)
  s_barrier
  s_xor_b32 s85, s84, 2
  s_lshl_b32 s86, s85, 7
  s_add_u32 s86, s86, s56
  s_add_u32 m0, s58, 106496
  s_add_u32 s60, s86, 0
  buffer_load_dwordx4 v3, s[28:31], s60 offen lds
  s_add_u32 m0, s58, 107520
  s_add_u32 s60, s86, 8192
  buffer_load_dwordx4 v4, s[28:31], s60 offen lds
  s_add_u32 m0, s58, 108544
  s_add_u32 s60, s86, 16384
  buffer_load_dwordx4 v3, s[28:31], s60 offen lds
  s_add_u32 m0, s58, 109568
  s_add_u32 s60, s86, 24576
  buffer_load_dwordx4 v4, s[28:31], s60 offen lds
  s_mul_i32 s86, s85, 196608
  s_add_u32 s86, s86, s57
  s_add_u32 m0, s59, 122880
  s_nop 0
  buffer_load_dwordx4 v5, s[32:35], s86 offen lds
  s_add_u32 m0, s59, 123904
  s_nop 0
  buffer_load_dwordx4 v6, s[32:35], s86 offen lds
  s_add_u32 m0, s59, 124928
  s_nop 0
  buffer_load_dwordx4 v7, s[32:35], s86 offen lds
  s_mul_i32 s86, s85, 176128
  s_add_u32 s86, s86, s57
  s_add_u32 m0, s59, 135168
  s_nop 0
  buffer_load_dwordx4 v8, s[40:43], s86 offen lds
  s_add_u32 m0, s59, 136192
  s_nop 0
  buffer_load_dwordx4 v9, s[40:43], s86 offen lds
  s_add_u32 m0, s59, 137216
  s_nop 0
  buffer_load_dwordx4 v10, s[40:43], s86 offen lds
  s_add_u32 m0, s59, 147456
  s_nop 0
  buffer_load_dwordx4 v8, s[44:47], s86 offen lds
  s_add_u32 m0, s59, 148480
  s_nop 0
  buffer_load_dwordx4 v9, s[44:47], s86 offen lds
  s_add_u32 m0, s59, 149504
  s_nop 0
  buffer_load_dwordx4 v10, s[44:47], s86 offen lds
  s_waitcnt vmcnt(13)
  s_barrier
  s_xor_b32 s85, s84, 3
  s_lshl_b32 s86, s85, 7
  s_add_u32 s86, s86, s56
  s_add_u32 m0, s58, 0
  s_add_u32 s60, s86, 0
  buffer_load_dwordx4 v3, s[28:31], s60 offen lds
  s_add_u32 m0, s58, 1024
  s_add_u32 s60, s86, 8192
  buffer_load_dwordx4 v4, s[28:31], s60 offen lds
  s_add_u32 m0, s58, 2048
  s_add_u32 s60, s86, 16384
  buffer_load_dwordx4 v3, s[28:31], s60 offen lds
  s_add_u32 m0, s58, 3072
  s_add_u32 s60, s86, 24576
  buffer_load_dwordx4 v4, s[28:31], s60 offen lds
  s_mul_i32 s86, s85, 196608
  s_add_u32 s86, s86, s57
  s_add_u32 m0, s59, 16384
  s_nop 0
  buffer_load_dwordx4 v5, s[32:35], s86 offen lds
  s_add_u32 m0, s59, 17408
  s_nop 0
  buffer_load_dwordx4 v6, s[32:35], s86 offen lds
  s_add_u32 m0, s59, 18432
  s_nop 0
  buffer_load_dwordx4 v7, s[32:35], s86 offen lds
  s_mul_i32 s86, s85, 176128
  s_add_u32 s86, s86, s57
  s_add_u32 m0, s59, 28672
  s_nop 0
  buffer_load_dwordx4 v8, s[40:43], s86 offen lds
  s_add_u32 m0, s59, 29696
  s_nop 0
  buffer_load_dwordx4 v9, s[40:43], s86 offen lds
  s_add_u32 m0, s59, 30720
  s_nop 0
  buffer_load_dwordx4 v10, s[40:43], s86 offen lds
  s_add_u32 m0, s59, 40960
  s_nop 0
  buffer_load_dwordx4 v8, s[44:47], s86 offen lds
  s_add_u32 m0, s59, 41984
  s_nop 0
  buffer_load_dwordx4 v9, s[44:47], s86 offen lds
  s_add_u32 m0, s59, 43008
  s_nop 0
  buffer_load_dwordx4 v10, s[44:47], s86 offen lds
  s_waitcnt vmcnt(13)
  s_barrier
  s_xor_b32 s85, s84, 4
  s_lshl_b32 s86, s85, 7
  s_add_u32 s86, s86, s56
  s_add_u32 m0, s58, 53248
  s_add_u32 s60, s86, 0
  buffer_load_dwordx4 v3, s[28:31], s60 offen lds
  s_add_u32 m0, s58, 54272
  s_add_u32 s60, s86, 8192
  buffer_load_dwordx4 v4, s[28:31], s60 offen lds
  s_add_u32 m0, s58, 55296
  s_add_u32 s60, s86, 16384
  buffer_load_dwordx4 v3, s[28:31], s60 offen lds
  s_add_u32 m0, s58, 56320
  s_add_u32 s60, s86, 24576
  buffer_load_dwordx4 v4, s[28:31], s60 offen lds
  s_mul_i32 s86, s85, 196608
  s_add_u32 s86, s86, s57
  s_add_u32 m0, s59, 69632
  s_nop 0
  buffer_load_dwordx4 v5, s[32:35], s86 offen lds
  s_add_u32 m0, s59, 70656
  s_nop 0
  buffer_load_dwordx4 v6, s[32:35], s86 offen lds
  s_add_u32 m0, s59, 71680
  s_nop 0
  buffer_load_dwordx4 v7, s[32:35], s86 offen lds
  s_mul_i32 s86, s85, 176128
  s_add_u32 s86, s86, s57
  s_add_u32 m0, s59, 81920
  s_nop 0
  buffer_load_dwordx4 v8, s[40:43], s86 offen lds
  s_add_u32 m0, s59, 82944
  s_nop 0
  buffer_load_dwordx4 v9, s[40:43], s86 offen lds
  s_add_u32 m0, s59, 83968
  s_nop 0
  buffer_load_dwordx4 v10, s[40:43], s86 offen lds
  s_add_u32 m0, s59, 94208
  s_nop 0
  buffer_load_dwordx4 v8, s[44:47], s86 offen lds
  s_add_u32 m0, s59, 95232
  s_nop 0
  buffer_load_dwordx4 v9, s[44:47], s86 offen lds
  s_add_u32 m0, s59, 96256
  s_nop 0
  buffer_load_dwordx4 v10, s[44:47], s86 offen lds
  s_waitcnt vmcnt(13)
  s_barrier
  s_xor_b32 s85, s84, 5
  s_lshl_b32 s86, s85, 7
  s_add_u32 s86, s86, s56
  s_add_u32 m0, s58, 106496
  s_add_u32 s60, s86, 0
  buffer_load_dwordx4 v3, s[28:31], s60 offen lds
  s_add_u32 m0, s58, 107520
  s_add_u32 s60, s86, 8192
  buffer_load_dwordx4 v4, s[28:31], s60 offen lds
  s_add_u32 m0, s58, 108544
  s_add_u32 s60, s86, 16384
  buffer_load_dwordx4 v3, s[28:31], s60 offen lds
  s_add_u32 m0, s58, 109568
  s_add_u32 s60, s86, 24576
  buffer_load_dwordx4 v4, s[28:31], s60 offen lds
  s_mul_i32 s86, s85, 196608
  s_add_u32 s86, s86, s57
  s_add_u32 m0, s59, 122880
  s_nop 0
  buffer_load_dwordx4 v5, s[32:35], s86 offen lds
  s_add_u32 m0, s59, 123904
  s_nop 0
  buffer_load_dwordx4 v6, s[32:35], s86 offen lds
  s_add_u32 m0, s59, 124928
  s_nop 0
  buffer_load_dwordx4 v7, s[32:35], s86 offen lds
  s_mul_i32 s86, s85, 176128
  s_add_u32 s86, s86, s57
  s_add_u32 m0, s59, 135168
  s_nop 0
  buffer_load_dwordx4 v8, s[40:43], s86 offen lds
  s_add_u32 m0, s59, 136192
  s_nop 0
  buffer_load_dwordx4 v9, s[40:43], s86 offen lds
  s_add_u32 m0, s59, 137216
  s_nop 0
  buffer_load_dwordx4 v10, s[40:43], s86 offen lds
  s_add_u32 m0, s59, 147456
  s_nop 0
  buffer_load_dwordx4 v8, s[44:47], s86 offen lds
  s_add_u32 m0, s59, 148480
  s_nop 0
  buffer_load_dwordx4 v9, s[44:47], s86 offen lds
  s_add_u32 m0, s59, 149504
  s_nop 0
  buffer_load_dwordx4 v10, s[44:47], s86 offen lds
  s_waitcnt vmcnt(13)
  s_barrier
  s_xor_b32 s85, s84, 6
  s_lshl_b32 s86, s85, 7
  s_add_u32 s86, s86, s56
  s_add_u32 m0, s58, 0
  s_add_u32 s60, s86, 0
  buffer_load_dwordx4 v3, s[28:31], s60 offen lds
  s_add_u32 m0, s58, 1024
  s_add_u32 s60, s86, 8192
  buffer_load_dwordx4 v4, s[28:31], s60 offen lds
  s_add_u32 m0, s58, 2048
  s_add_u32 s60, s86, 16384
  buffer_load_dwordx4 v3, s[28:31], s60 offen lds
  s_add_u32 m0, s58, 3072
  s_add_u32 s60, s86, 24576
  buffer_load_dwordx4 v4, s[28:31], s60 offen lds
  s_mul_i32 s86, s85, 196608
  s_add_u32 s86, s86, s57
  s_add_u32 m0, s59, 16384
  s_nop 0
  buffer_load_dwordx4 v5, s[32:35], s86 offen lds
  s_add_u32 m0, s59, 17408
  s_nop 0
  buffer_load_dwordx4 v6, s[32:35], s86 offen lds
  s_add_u32 m0, s59, 18432
  s_nop 0
  buffer_load_dwordx4 v7, s[32:35], s86 offen lds
  s_mul_i32 s86, s85, 176128
  s_add_u32 s86, s86, s57
  s_add_u32 m0, s59, 28672
  s_nop 0
  buffer_load_dwordx4 v8, s[40:43], s86 offen lds
  s_add_u32 m0, s59, 29696
  s_nop 0
  buffer_load_dwordx4 v9, s[40:43], s86 offen lds
  s_add_u32 m0, s59, 30720
  s_nop 0
  buffer_load_dwordx4 v10, s[40:43], s86 offen lds
  s_add_u32 m0, s59, 40960
  s_nop 0
  buffer_load_dwordx4 v8, s[44:47], s86 offen lds
  s_add_u32 m0, s59, 41984
  s_nop 0
  buffer_load_dwordx4 v9, s[44:47], s86 offen lds
  s_add_u32 m0, s59, 43008
  s_nop 0
  buffer_load_dwordx4 v10, s[44:47], s86 offen lds
  s_waitcnt vmcnt(13)
  s_barrier
  s_xor_b32 s85, s84, 7
  s_lshl_b32 s86, s85, 7
  s_add_u32 s86, s86, s56
  s_add_u32 m0, s58, 53248
  s_add_u32 s60, s86, 0
  buffer_load_dwordx4 v3, s[28:31], s60 offen lds
  s_add_u32 m0, s58, 54272
  s_add_u32 s60, s86, 8192
  buffer_load_dwordx4 v4, s[28:31], s60 offen lds
  s_add_u32 m0, s58, 55296
  s_add_u32 s60, s86, 16384
  buffer_load_dwordx4 v3, s[28:31], s60 offen lds
  s_add_u32 m0, s58, 56320
  s_add_u32 s60, s86, 24576
  buffer_load_dwordx4 v4, s[28:31], s60 offen lds
  s_mul_i32 s86, s85, 196608
  s_add_u32 s86, s86, s57
  s_add_u32 m0, s59, 69632
  s_nop 0
  buffer_load_dwordx4 v5, s[32:35], s86 offen lds
  s_add_u32 m0, s59, 70656
  s_nop 0
  buffer_load_dwordx4 v6, s[32:35], s86 offen lds
  s_add_u32 m0, s59, 71680
  s_nop 0
  buffer_load_dwordx4 v7, s[32:35], s86 offen lds
  s_mul_i32 s86, s85, 176128
  s_add_u32 s86, s86, s57
  s_add_u32 m0, s59, 81920
  s_nop 0
  buffer_load_dwordx4 v8, s[40:43], s86 offen lds
  s_add_u32 m0, s59, 82944
  s_nop 0
  buffer_load_dwordx4 v9, s[40:43], s86 offen lds
  s_add_u32 m0, s59, 83968
  s_nop 0
  buffer_load_dwordx4 v10, s[40:43], s86 offen lds
  s_add_u32 m0, s59, 94208
  s_nop 0
  buffer_load_dwordx4 v8, s[44:47], s86 offen lds
  s_add_u32 m0, s59, 95232
  s_nop 0
  buffer_load_dwordx4 v9, s[44:47], s86 offen lds
  s_add_u32 m0, s59, 96256
  s_nop 0
  buffer_load_dwordx4 v10, s[44:47], s86 offen lds
  s_waitcnt vmcnt(13)
  s_barrier
  s_lshl_b32 s70, s2, 2
  s_add_u32 s70, s70, s49
  v_lshrrev_b32 v23, 2, v1
  v_and_b32 v24, 3, v1
  v_lshlrev_b32 v24, 4, v24
  v_lshl_add_u32 v26, v23, 10, v24
  s_lshl_b32 s71, s49, 11
  s_add_u32 s71, s71, 106496
  s_add_u32 s77, s70, 0
  s_cmp_ge_u32 s77, 1376
  s_cselect_b32 s80, s8, s16
  s_cselect_b32 s81, s9, s17
  s_mov_b32 s82, 1409024
  s_cselect_b32 s82, 524288, s82
  s_cselect_b32 s78, 1376, 0
  s_cselect_b32 s79, 0, 32
  s_and_b32 s81, s81, 0xffff
  s_mov_b32 s83, 0x00020000
  s_sub_u32 s77, s77, s78
  s_lshr_b32 s78, s77, 4
  s_and_b32 s77, s77, 15
  s_lshl_b32 s74, s78, 14
  s_lshl_b32 s75, s77, 6
  s_add_u32 s74, s74, s75
  s_mul_i32 s77, s77, 118
  s_add_u32 s77, s77, s78
  s_add_u32 s77, s77, s79
  s_lshl_b32 s77, s77, 10
  s_add_u32 s72, s77, 17825792
  s_add_u32 m0, s71, 0
  s_nop 0
  buffer_load_dwordx4 v26, s[80:83], s74 offen lds
  s_add_u32 s77, s70, 1024
  s_cmp_ge_u32 s77, 1888
  s_cselect_b32 s78, 1888, 0
  s_sub_u32 s77, s77, s78
  s_cmp_ge_u32 s77, 1376
  s_cselect_b32 s80, s8, s16
  s_cselect_b32 s81, s9, s17
  s_mov_b32 s82, 1409024
  s_cselect_b32 s82, 524288, s82
  s_cselect_b32 s78, 1376, 0
  s_cselect_b32 s79, 0, 32
  s_and_b32 s81, s81, 0xffff
  s_mov_b32 s83, 0x00020000
  s_sub_u32 s77, s77, s78
  s_lshr_b32 s78, s77, 4
  s_and_b32 s77, s77, 15
  s_lshl_b32 s74, s78, 14
  s_lshl_b32 s75, s77, 6
  s_add_u32 s74, s74, s75
  s_mul_i32 s77, s77, 118
  s_add_u32 s77, s77, s78
  s_add_u32 s77, s77, s79
  s_lshl_b32 s77, s77, 10
  s_add_u32 s73, s77, 17825792
  s_add_u32 m0, s71, 1024
  s_nop 0
  buffer_load_dwordx4 v26, s[80:83], s74 offen lds
  s_mov_b32 s80, s18
  s_and_b32 s81, s19, 0xffff
  s_mov_b32 s82, 1024
  s_mov_b32 s83, 0x00020000
  s_lshl_b32 s54, s51, 7
  s_lshl_b32 s55, s52, 3
  s_add_u32 s54, s54, s55
  s_lshl_b32 s55, s49, 1
  s_add_u32 s54, s54, s55
  s_lshl_b32 s55, s54, 10
  buffer_load_dwordx4 v[112:115], v14, s[28:31], s55 offen
  buffer_load_dwordx4 v[116:119], v14, s[28:31], s55 offen offset:1024
  buffer_load_dwordx4 v[120:123], v14, s[80:83], 0 offen
  s_waitcnt vmcnt(5)
  s_barrier
  s_waitcnt vmcnt(0)
  v_and_b32 v17, 15, v1
  v_lshrrev_b32 v18, 2, v17
  v_lshrrev_b32 v19, 4, v1
  v_and_b32 v19, 1, v19
  v_lshlrev_b32 v19, 5, v19
  v_and_b32 v17, 3, v17
  v_lshl_add_u32 v19, v17, 3, v19
  v_lshrrev_b32 v20, 5, v1
  v_lshl_add_u32 v21, v20, 2, v18
  v_lshl_add_u32 v21, v21, 6, v19
  v_add_u32 v21, s71, v21
  ds_read_b64_tr_b16 v[80:81], v21 offset:0
  ds_read_b64_tr_b16 v[82:83], v21 offset:512
  ds_read_b64_tr_b16 v[84:85], v21 offset:1024
  ds_read_b64_tr_b16 v[86:87], v21 offset:1536
  s_waitcnt lgkmcnt(2)
  buffer_store_dwordx4 v[80:83], v14, s[36:39], s72 offen sc1
  s_waitcnt lgkmcnt(0)
  buffer_store_dwordx4 v[84:87], v14, s[36:39], s73 offen sc1
  v_lshlrev_b32 v100, 16, v120
  v_and_b32 v101, 0xffff0000, v120
  v_lshlrev_b32 v102, 16, v121
  v_and_b32 v103, 0xffff0000, v121
  v_lshlrev_b32 v104, 16, v122
  v_and_b32 v105, 0xffff0000, v122
  v_lshlrev_b32 v106, 16, v123
  v_and_b32 v107, 0xffff0000, v123
  v_lshlrev_b32 v110, 16, v112
  v_and_b32 v111, 0xffff0000, v112
  v_mul_f32 v108, v110, v100
  v_fmac_f32 v108, v111, v101
  v_lshlrev_b32 v110, 16, v113
  v_and_b32 v111, 0xffff0000, v113
  v_fmac_f32 v108, v110, v102
  v_fmac_f32 v108, v111, v103
  v_lshlrev_b32 v110, 16, v114
  v_and_b32 v111, 0xffff0000, v114
  v_fmac_f32 v108, v110, v104
  v_fmac_f32 v108, v111, v105
  v_lshlrev_b32 v110, 16, v115
  v_and_b32 v111, 0xffff0000, v115
  v_fmac_f32 v108, v110, v106
  v_fmac_f32 v108, v111, v107
  s_nop 1
  v_add_f32_dpp v108, v108, v108 quad_perm:[1,0,3,2] row_mask:0xf bank_mask:0xf
  s_nop 1
  v_add_f32_dpp v108, v108, v108 quad_perm:[2,3,0,1] row_mask:0xf bank_mask:0xf
  s_nop 1
  v_add_f32_dpp v108, v108, v108 row_half_mirror row_mask:0xf bank_mask:0xf
  s_nop 1
  v_add_f32_dpp v108, v108, v108 row_mirror row_mask:0xf bank_mask:0xf
  s_nop 1
  v_readlane_b32 s82, v108, 0
  v_readlane_b32 s83, v108, 16
  v_readlane_b32 s84, v108, 32
  v_readlane_b32 s85, v108, 48
  s_nop 1
  v_mov_b32 v108, s82
  v_add_f32 v108, s83, v108
  v_add_f32 v108, s84, v108
  v_add_f32 v108, s85, v108
  v_mul_f32 v108, 0xbfb8aa3b, v108
  v_exp_f32 v108, v108
  s_nop 0
  v_add_f32 v108, 1.0, v108
  v_rcp_f32 v108, v108
  s_nop 0
  v_lshlrev_b32 v110, 16, v116
  v_and_b32 v111, 0xffff0000, v116
  v_mul_f32 v109, v110, v100
  v_fmac_f32 v109, v111, v101
  v_lshlrev_b32 v110, 16, v117
  v_and_b32 v111, 0xffff0000, v117
  v_fmac_f32 v109, v110, v102
  v_fmac_f32 v109, v111, v103
  v_lshlrev_b32 v110, 16, v118
  v_and_b32 v111, 0xffff0000, v118
  v_fmac_f32 v109, v110, v104
  v_fmac_f32 v109, v111, v105
  v_lshlrev_b32 v110, 16, v119
  v_and_b32 v111, 0xffff0000, v119
  v_fmac_f32 v109, v110, v106
  v_fmac_f32 v109, v111, v107
  s_nop 1
  v_add_f32_dpp v109, v109, v109 quad_perm:[1,0,3,2] row_mask:0xf bank_mask:0xf
  s_nop 1
  v_add_f32_dpp v109, v109, v109 quad_perm:[2,3,0,1] row_mask:0xf bank_mask:0xf
  s_nop 1
  v_add_f32_dpp v109, v109, v109 row_half_mirror row_mask:0xf bank_mask:0xf
  s_nop 1
  v_add_f32_dpp v109, v109, v109 row_mirror row_mask:0xf bank_mask:0xf
  s_nop 1
  v_readlane_b32 s82, v109, 0
  v_readlane_b32 s83, v109, 16
  v_readlane_b32 s84, v109, 32
  v_readlane_b32 s85, v109, 48
  s_nop 1
  v_mov_b32 v109, s82
  v_add_f32 v109, s83, v109
  v_add_f32 v109, s84, v109
  v_add_f32 v109, s85, v109
  v_mul_f32 v109, 0xbfb8aa3b, v109
  v_exp_f32 v109, v109
  s_nop 0
  v_add_f32 v109, 1.0, v109
  v_rcp_f32 v109, v109
  s_nop 0
  s_lshl_b32 s82, s54, 2
  s_add_u32 s82, s82, 19922944
  v_mov_b32 v110, 0
  v_cmp_eq_u32 vcc, 0, v1
  s_and_saveexec_b64 s[66:67], vcc
  buffer_store_dword v108, v110, s[36:39], s82 offen
  buffer_store_dword v109, v110, s[36:39], s82 offen offset:4
  s_mov_b64 exec, s[66:67]
  s_add_u32 s48, s49, 8
k1_qkv_kernel_end:
  s_endpgm
.globl k2_attn_kernel
.p2align 8
.type k2_attn_kernel,@function
k2_attn_kernel:
  s_cmp_ge_u32 s2, 256
  s_cbranch_scc1 k2_attn_kernel_end
  s_load_dwordx2 s[6:7], s[0:1], 80
  v_and_b32 v1, 63, v0
  v_lshrrev_b32 v2, 6, v0
  s_nop 0
  v_readfirstlane_b32 s48, v2
  s_and_b32 s49, s2, 7
  s_lshr_b32 s50, s2, 3
  s_and_b32 s51, s50, 3
  s_lshl_b32 s51, s51, 3
  s_add_u32 s51, s51, s49
  s_lshr_b32 s52, s50, 2
  v_lshlrev_b32 v4, 4, v1
  s_cmp_ge_u32 s48, 8
  s_cbranch_scc1 k2_attn_kernel_gemm
  s_lshl_b32 s53, s52, 3
  s_add_u32 s53, s53, s48
  v_lshlrev_b32 v5, 2, v1
  v_and_b32 v12, 31, v1
  v_lshlrev_b32 v12, 2, v12
  s_lshl_b32 s54, s51, 6
  s_add_u32 s54, s54, s53
  s_lshl_b32 s54, s54, 10
  s_add_u32 s54, s54, 0
  s_lshl_b32 s55, s51, 8
  s_add_u32 s55, s55, 19939328
  s_lshl_b32 s56, s53, 7
  s_add_u32 s56, s56, 19922944
  s_waitcnt lgkmcnt(0)
  s_mov_b32 s36, s6
  s_and_b32 s37, s7, 0xffff
  s_mov_b32 s38, 33554432
  s_mov_b32 s39, 0x00020000
  buffer_load_dwordx4 v[8:11], v4, s[36:39], s54 offen
  buffer_load_dword v6, v5, s[36:39], s55 offen
  buffer_load_dword v7, v12, s[36:39], s56 offen
  v_and_b32 v12, 1, v0
  v_cmp_eq_u32 vcc, 0, v12
  v_mov_b32 v13, 0x3f80
  v_mov_b32 v25, 0
  v_mov_b32 v27, 0
  v_cndmask_b32 v24, 0, v13, vcc
  v_mov_b32 v28, 0
  v_mov_b32 v29, 0
  v_mov_b32 v30, 0
  v_mov_b32 v31, 0
  v_mov_b32 v26, v24
  v_lshlrev_b32 v12, 4, v0
  v_add_u32 v12, 131072, v12
  v_mov_b32 v13, 147456
  ds_write_b128 v12, v[24:27]
  ds_write_b128 v12, v[24:27] offset:8192
  ds_write_b128 v13, v[28:31]
  s_waitcnt lgkmcnt(0)
  s_barrier
  v_lshrrev_b32 v14, 5, v1
  v_and_b32 v15, 15, v1
  v_lshrrev_b32 v16, 2, v15
  v_lshl_add_u32 v16, v14, 2, v16
  v_lshlrev_b32 v16, 5, v16
  v_and_b32 v17, 1, v15
  v_lshl_add_u32 v16, v17, 4, v16
  v_lshrrev_b32 v17, 1, v15
  v_and_b32 v17, 1, v17
  v_lshl_add_u32 v16, v17, 3, v16
  v_add_u32 v16, 0x10000, v16
  v_xor_b32 v17, 1, v14
  v_lshlrev_b32 v17, 7, v17
  v_and_b32 v18, 3, v15
  v_lshl_add_u32 v17, v18, 3, v17
  v_add_u32 v17, 131072, v17
  v_and_b32 v18, 16, v1
  v_cmp_eq_u32 vcc, 0, v18
  v_mov_b32 v18, 8192
  v_mov_b32 v22, 147456
  s_nop 0
  v_cndmask_b32 v15, v17, v16, vcc
  v_cndmask_b32 v21, 0, v18, vcc
  s_waitcnt vmcnt(0)
  v_lshlrev_b32 v16, 16, v8
  v_and_b32 v17, 0xffff0000, v8
  v_mul_f32 v18, v16, v16
  v_fmac_f32 v18, v17, v17
  v_lshlrev_b32 v16, 16, v9
  v_and_b32 v17, 0xffff0000, v9
  v_fmac_f32 v18, v16, v16
  v_fmac_f32 v18, v17, v17
  v_lshlrev_b32 v16, 16, v10
  v_and_b32 v17, 0xffff0000, v10
  v_fmac_f32 v18, v16, v16
  v_fmac_f32 v18, v17, v17
  v_lshlrev_b32 v16, 16, v11
  v_and_b32 v17, 0xffff0000, v11
  v_fmac_f32 v18, v16, v16
  v_fmac_f32 v18, v17, v17
  v_mov_b32 v19, v18
  s_nop 1
  v_permlane32_swap_b32 v18, v19
  s_nop 1
  v_add_f32 v18, v18, v19
  s_nop 1
  v_max_f32_dpp v6, v6, v6 quad_perm:[1,0,3,2] row_mask:0xf bank_mask:0xf
  s_nop 1
  v_max_f32_dpp v6, v6, v6 quad_perm:[2,3,0,1] row_mask:0xf bank_mask:0xf
  s_nop 1
  v_max_f32_dpp v6, v6, v6 row_half_mirror row_mask:0xf bank_mask:0xf
  s_nop 1
  v_max_f32_dpp v6, v6, v6 row_mirror row_mask:0xf bank_mask:0xf
  s_nop 1
  v_readlane_b32 s62, v6, 0
  v_readlane_b32 s63, v6, 16
  v_readlane_b32 s64, v6, 32
  v_readlane_b32 s65, v6, 48
  s_nop 1
  v_mov_b32 v6, s62
  v_max_f32 v6, s63, v6
  v_max_f32 v6, s64, v6
  v_max_f32 v6, s65, v6
  v_mul_f32 v18, v18, v6
  v_sqrt_f32 v18, v18
  s_nop 0
  v_mul_f32 v18, 0x3f828f5c, v18
  s_mov_b32 s68, 0
  v_cmp_lt_f32 vcc, 0x42200000, v18
  v_lshlrev_b32 v14, 4, v1
  s_nop 1
  s_cbranch_vccz k2_attn_kernel_fast
  s_cmp_ge_u32 s68, 3
  s_cbranch_scc1 k2_attn_kernel_ok0
k2_attn_kernel_sp0:
  ds_read_b128 v[24:27], v22
  s_waitcnt lgkmcnt(0)
  v_min_u32 v24, v24, v25
  v_min_u32 v26, v26, v27
  v_min_u32 v24, v24, v26
  s_nop 0
  v_readfirstlane_b32 s68, v24
  s_nop 3
  s_cmp_ge_u32 s68, 3
  s_cbranch_scc0 k2_attn_kernel_sp0
k2_attn_kernel_ok0:
  v_mov_b32 v18, 0xff7fffff
  s_mov_b32 s66, 0
  v_mov_b32 v20, v14
k2_attn_kernel_mx:
  ds_read_b128 v[104:107], v20
  s_waitcnt lgkmcnt(0)
  v_mfma_f32_32x32x16_bf16 v[32:47], v[104:107], v[8:11], 0
  s_nop 15
  s_nop 3
  v_max3_f32 v18, v18, v32, v33
  v_max3_f32 v18, v18, v34, v35
  v_max3_f32 v18, v18, v36, v37
  v_max3_f32 v18, v18, v38, v39
  v_max3_f32 v18, v18, v40, v41
  v_max3_f32 v18, v18, v42, v43
  v_max3_f32 v18, v18, v44, v45
  v_max3_f32 v18, v18, v46, v47
  v_add_u32 v20, 1024, v20
  s_add_u32 s66, s66, 1
  s_cmp_lt_u32 s66, 64
  s_cbranch_scc1 k2_attn_kernel_mx
  v_mov_b32 v19, v18
  s_nop 1
  v_permlane32_swap_b32 v18, v19
  s_nop 1
  v_max_f32 v18, v18, v19
k2_attn_kernel_fast:
  v_sub_f32 v64, 0, v18
  v_sub_f32 v65, 0, v18
  v_sub_f32 v66, 0, v18
  v_sub_f32 v67, 0, v18
  v_sub_f32 v68, 0, v18
  v_sub_f32 v69, 0, v18
  v_sub_f32 v70, 0, v18
  v_sub_f32 v71, 0, v18
  v_sub_f32 v72, 0, v18
  v_sub_f32 v73, 0, v18
  v_sub_f32 v74, 0, v18
  v_sub_f32 v75, 0, v18
  v_sub_f32 v76, 0, v18
  v_sub_f32 v77, 0, v18
  v_sub_f32 v78, 0, v18
  v_sub_f32 v79, 0, v18
  v_mov_b32 v80, 0
  v_mov_b32 v81, 0
  v_mov_b32 v82, 0
  v_mov_b32 v83, 0
  v_mov_b32 v84, 0
  v_mov_b32 v85, 0
  v_mov_b32 v86, 0
  v_mov_b32 v87, 0
  v_mov_b32 v88, 0
  v_mov_b32 v89, 0
  v_mov_b32 v90, 0
  v_mov_b32 v91, 0
  v_mov_b32 v92, 0
  v_mov_b32 v93, 0
  v_mov_b32 v94, 0
  v_mov_b32 v95, 0
  v_mov_b32 v100, 0
  v_mov_b32 v101, 0
  v_mov_b32 v102, 0
  v_mov_b32 v103, 0
  v_mov_b32 v124, 0
  v_mov_b32 v125, 0
  v_mov_b32 v126, 0
  v_mov_b32 v127, 0
  v_mov_b32 v62, 0
  v_mov_b32 v63, 0
  s_cmp_ge_u32 s68, 1
  s_cbranch_scc1 k2_attn_kernel_ok1
k2_attn_kernel_sp1:
  ds_read_b128 v[24:27], v22
  s_waitcnt lgkmcnt(0)
  v_min_u32 v24, v24, v25
  v_min_u32 v26, v26, v27
  v_min_u32 v24, v24, v26
  s_nop 0
  v_readfirstlane_b32 s68, v24
  s_nop 3
  s_cmp_ge_u32 s68, 1
  s_cbranch_scc0 k2_attn_kernel_sp1
k2_attn_kernel_ok1:
  ds_read_b128 v[104:107], v14 offset:0
  s_waitcnt lgkmcnt(0)
  v_mfma_f32_32x32x16_bf16 v[32:47], v[104:107], v[8:11], v[64:79]
  ds_read_b128 v[108:111], v14 offset:1024
  ds_read_b64_tr_b16 v[112:113], v15 offset:0
  ds_read_b64_tr_b16 v[114:115], v15 offset:256
  ds_read_b64_tr_b16 v[116:117], v15 offset:512
  ds_read_b64_tr_b16 v[118:119], v15 offset:768
  s_mov_b32 s66, 0
  s_mov_b32 s69, 1
  s_cmp_ge_u32 s48, 4
  s_cbranch_scc0 k2_attn_kernel_noprio
  s_setprio 1
k2_attn_kernel_noprio:
  s_nop 7
  s_nop 7
  .p2align 6
k2_attn_kernel_loop:
  v_exp_f32 v32, v32
  v_exp_f32 v33, v33
  v_cvt_pk_bf16_f32 v103, v62, v63
  ds_read_b128 v[104:107], v14 offset:2048
  v_exp_f32 v34, v34
  v_mfma_f32_32x32x16_bf16 v[80:95], v[124:127], v[100:103], v[80:95]
  ds_read_b64_tr_b16 v[120:121], v15 offset:1024
  ds_read_b64_tr_b16 v[122:123], v15 offset:1280
  ds_read_b64_tr_b16 v[124:125], v15 offset:1536
  ds_read_b64_tr_b16 v[126:127], v15 offset:1792
  v_exp_f32 v35, v35
  v_cvt_pk_bf16_f32 v96, v32, v33
  v_exp_f32 v36, v36
  v_exp_f32 v37, v37
  v_cvt_pk_bf16_f32 v97, v34, v35
  v_exp_f32 v38, v38
  s_waitcnt lgkmcnt(5)
  v_mfma_f32_32x32x16_bf16 v[48:63], v[108:111], v[8:11], v[64:79]
  v_exp_f32 v39, v39
  v_cvt_pk_bf16_f32 v98, v36, v37
  v_exp_f32 v40, v40
  v_exp_f32 v41, v41
  v_cvt_pk_bf16_f32 v99, v38, v39
  v_exp_f32 v42, v42
  v_exp_f32 v43, v43
  v_mfma_f32_32x32x16_bf16 v[80:95], v[112:115], v[96:99], v[80:95]
  v_cvt_pk_bf16_f32 v100, v40, v41
  v_exp_f32 v44, v44
  v_exp_f32 v45, v45
  v_cvt_pk_bf16_f32 v101, v42, v43
  v_exp_f32 v46, v46
  v_exp_f32 v47, v47
  v_cvt_pk_bf16_f32 v102, v44, v45
  v_exp_f32 v48, v48
  v_exp_f32 v49, v49
  v_cvt_pk_bf16_f32 v103, v46, v47
  ds_read_b128 v[108:111], v14 offset:3072
  v_exp_f32 v50, v50
  v_mfma_f32_32x32x16_bf16 v[80:95], v[116:119], v[100:103], v[80:95]
  ds_read_b64_tr_b16 v[112:113], v15 offset:2048
  ds_read_b64_tr_b16 v[114:115], v15 offset:2304
  ds_read_b64_tr_b16 v[116:117], v15 offset:2560
  ds_read_b64_tr_b16 v[118:119], v15 offset:2816
  v_exp_f32 v51, v51
  v_cvt_pk_bf16_f32 v96, v48, v49
  v_exp_f32 v52, v52
  v_exp_f32 v53, v53
  v_cvt_pk_bf16_f32 v97, v50, v51
  v_exp_f32 v54, v54
  s_waitcnt lgkmcnt(5)
  v_mfma_f32_32x32x16_bf16 v[32:47], v[104:107], v[8:11], v[64:79]
  v_exp_f32 v55, v55
  v_cvt_pk_bf16_f32 v98, v52, v53
  v_exp_f32 v56, v56
  v_exp_f32 v57, v57
  v_cvt_pk_bf16_f32 v99, v54, v55
  v_exp_f32 v58, v58
  v_exp_f32 v59, v59
  v_mfma_f32_32x32x16_bf16 v[80:95], v[120:123], v[96:99], v[80:95]
  v_cvt_pk_bf16_f32 v100, v56, v57
  v_exp_f32 v60, v60
  v_exp_f32 v61, v61
  v_cvt_pk_bf16_f32 v101, v58, v59
  v_exp_f32 v62, v62
  v_exp_f32 v63, v63
  v_cvt_pk_bf16_f32 v102, v60, v61
  v_exp_f32 v32, v32
  v_exp_f32 v33, v33
  v_cvt_pk_bf16_f32 v103, v62, v63
  ds_read_b128 v[104:107], v14 offset:4096
  v_exp_f32 v34, v34
  v_mfma_f32_32x32x16_bf16 v[80:95], v[124:127], v[100:103], v[80:95]
  ds_read_b64_tr_b16 v[120:121], v15 offset:3072
  ds_read_b64_tr_b16 v[122:123], v15 offset:3328
  ds_read_b64_tr_b16 v[124:125], v15 offset:3584
  ds_read_b64_tr_b16 v[126:127], v15 offset:3840
  v_exp_f32 v35, v35
  v_cvt_pk_bf16_f32 v96, v32, v33
  v_exp_f32 v36, v36
  v_exp_f32 v37, v37
  v_cvt_pk_bf16_f32 v97, v34, v35
  v_exp_f32 v38, v38
  s_waitcnt lgkmcnt(5)
  v_mfma_f32_32x32x16_bf16 v[48:63], v[108:111], v[8:11], v[64:79]
  v_exp_f32 v39, v39
  v_cvt_pk_bf16_f32 v98, v36, v37
  v_exp_f32 v40, v40
  v_exp_f32 v41, v41
  v_cvt_pk_bf16_f32 v99, v38, v39
  v_exp_f32 v42, v42
  v_exp_f32 v43, v43
  v_mfma_f32_32x32x16_bf16 v[80:95], v[112:115], v[96:99], v[80:95]
  v_cvt_pk_bf16_f32 v100, v40, v41
  v_exp_f32 v44, v44
  v_exp_f32 v45, v45
  v_cvt_pk_bf16_f32 v101, v42, v43
  v_exp_f32 v46, v46
  v_exp_f32 v47, v47
  v_cvt_pk_bf16_f32 v102, v44, v45
  v_exp_f32 v48, v48
  v_exp_f32 v49, v49
  v_cvt_pk_bf16_f32 v103, v46, v47
  ds_read_b128 v[108:111], v14 offset:5120
  v_exp_f32 v50, v50
  v_mfma_f32_32x32x16_bf16 v[80:95], v[116:119], v[100:103], v[80:95]
  ds_read_b64_tr_b16 v[112:113], v15 offset:4096
  ds_read_b64_tr_b16 v[114:115], v15 offset:4352
  ds_read_b64_tr_b16 v[116:117], v15 offset:4608
  ds_read_b64_tr_b16 v[118:119], v15 offset:4864
  v_exp_f32 v51, v51
  v_cvt_pk_bf16_f32 v96, v48, v49
  v_exp_f32 v52, v52
  v_exp_f32 v53, v53
  v_cvt_pk_bf16_f32 v97, v50, v51
  v_exp_f32 v54, v54
  s_waitcnt lgkmcnt(5)
  v_mfma_f32_32x32x16_bf16 v[32:47], v[104:107], v[8:11], v[64:79]
  v_exp_f32 v55, v55
  v_cvt_pk_bf16_f32 v98, v52, v53
  v_exp_f32 v56, v56
  v_exp_f32 v57, v57
  v_cvt_pk_bf16_f32 v99, v54, v55
  v_exp_f32 v58, v58
  v_exp_f32 v59, v59
  v_mfma_f32_32x32x16_bf16 v[80:95], v[120:123], v[96:99], v[80:95]
  v_cvt_pk_bf16_f32 v100, v56, v57
  v_exp_f32 v60, v60
  v_exp_f32 v61, v61
  v_cvt_pk_bf16_f32 v101, v58, v59
  v_exp_f32 v62, v62
  v_exp_f32 v63, v63
  v_cvt_pk_bf16_f32 v102, v60, v61
  v_exp_f32 v32, v32
  v_exp_f32 v33, v33
  v_cvt_pk_bf16_f32 v103, v62, v63
  ds_read_b128 v[104:107], v14 offset:6144
  v_exp_f32 v34, v34
  v_mfma_f32_32x32x16_bf16 v[80:95], v[124:127], v[100:103], v[80:95]
  ds_read_b64_tr_b16 v[120:121], v15 offset:5120
  ds_read_b64_tr_b16 v[122:123], v15 offset:5376
  ds_read_b64_tr_b16 v[124:125], v15 offset:5632
  ds_read_b64_tr_b16 v[126:127], v15 offset:5888
  v_exp_f32 v35, v35
  v_cvt_pk_bf16_f32 v96, v32, v33
  v_exp_f32 v36, v36
  v_exp_f32 v37, v37
  v_cvt_pk_bf16_f32 v97, v34, v35
  v_exp_f32 v38, v38
  s_waitcnt lgkmcnt(5)
  v_mfma_f32_32x32x16_bf16 v[48:63], v[108:111], v[8:11], v[64:79]
  v_exp_f32 v39, v39
  v_cvt_pk_bf16_f32 v98, v36, v37
  v_exp_f32 v40, v40
  v_exp_f32 v41, v41
  v_cvt_pk_bf16_f32 v99, v38, v39
  v_exp_f32 v42, v42
  v_exp_f32 v43, v43
  v_mfma_f32_32x32x16_bf16 v[80:95], v[112:115], v[96:99], v[80:95]
  v_cvt_pk_bf16_f32 v100, v40, v41
  v_exp_f32 v44, v44
  v_exp_f32 v45, v45
  v_cvt_pk_bf16_f32 v101, v42, v43
  v_exp_f32 v46, v46
  v_exp_f32 v47, v47
  v_cvt_pk_bf16_f32 v102, v44, v45
  v_exp_f32 v48, v48
  v_exp_f32 v49, v49
  v_cvt_pk_bf16_f32 v103, v46, v47
  ds_read_b128 v[108:111], v14 offset:7168
  v_exp_f32 v50, v50
  v_mfma_f32_32x32x16_bf16 v[80:95], v[116:119], v[100:103], v[80:95]
  ds_read_b64_tr_b16 v[112:113], v15 offset:6144
  ds_read_b64_tr_b16 v[114:115], v15 offset:6400
  ds_read_b64_tr_b16 v[116:117], v15 offset:6656
  ds_read_b64_tr_b16 v[118:119], v15 offset:6912
  v_exp_f32 v51, v51
  v_cvt_pk_bf16_f32 v96, v48, v49
  v_exp_f32 v52, v52
  v_exp_f32 v53, v53
  v_cvt_pk_bf16_f32 v97, v50, v51
  v_exp_f32 v54, v54
  s_waitcnt lgkmcnt(5)
  v_mfma_f32_32x32x16_bf16 v[32:47], v[104:107], v[8:11], v[64:79]
  v_exp_f32 v55, v55
  v_cvt_pk_bf16_f32 v98, v52, v53
  v_exp_f32 v56, v56
  v_exp_f32 v57, v57
  v_cvt_pk_bf16_f32 v99, v54, v55
  v_exp_f32 v58, v58
  v_exp_f32 v59, v59
  v_mfma_f32_32x32x16_bf16 v[80:95], v[120:123], v[96:99], v[80:95]
  v_cvt_pk_bf16_f32 v100, v56, v57
  v_exp_f32 v60, v60
  v_exp_f32 v61, v61
  v_cvt_pk_bf16_f32 v101, v58, v59
  v_exp_f32 v62, v62
  v_exp_f32 v63, v63
  v_cvt_pk_bf16_f32 v102, v60, v61
  v_exp_f32 v32, v32
  v_exp_f32 v33, v33
  v_cvt_pk_bf16_f32 v103, v62, v63
  ds_read_b128 v[104:107], v14 offset:8192
  v_exp_f32 v34, v34
  v_mfma_f32_32x32x16_bf16 v[80:95], v[124:127], v[100:103], v[80:95]
  ds_read_b64_tr_b16 v[120:121], v15 offset:7168
  ds_read_b64_tr_b16 v[122:123], v15 offset:7424
  ds_read_b64_tr_b16 v[124:125], v15 offset:7680
  ds_read_b64_tr_b16 v[126:127], v15 offset:7936
  v_exp_f32 v35, v35
  v_cvt_pk_bf16_f32 v96, v32, v33
  v_exp_f32 v36, v36
  v_exp_f32 v37, v37
  v_cvt_pk_bf16_f32 v97, v34, v35
  v_exp_f32 v38, v38
  s_waitcnt lgkmcnt(5)
  v_mfma_f32_32x32x16_bf16 v[48:63], v[108:111], v[8:11], v[64:79]
  v_exp_f32 v39, v39
  v_cvt_pk_bf16_f32 v98, v36, v37
  v_exp_f32 v40, v40
  v_exp_f32 v41, v41
  v_cvt_pk_bf16_f32 v99, v38, v39
  v_exp_f32 v42, v42
  v_exp_f32 v43, v43
  v_mfma_f32_32x32x16_bf16 v[80:95], v[112:115], v[96:99], v[80:95]
  v_cvt_pk_bf16_f32 v100, v40, v41
  v_exp_f32 v44, v44
  v_exp_f32 v45, v45
  v_cvt_pk_bf16_f32 v101, v42, v43
  v_exp_f32 v46, v46
  v_exp_f32 v47, v47
  v_cvt_pk_bf16_f32 v102, v44, v45
  v_exp_f32 v48, v48
  v_exp_f32 v49, v49
  v_cvt_pk_bf16_f32 v103, v46, v47
  ds_read_b128 v[108:111], v14 offset:9216
  v_exp_f32 v50, v50
  v_mfma_f32_32x32x16_bf16 v[80:95], v[116:119], v[100:103], v[80:95]
  ds_read_b64_tr_b16 v[112:113], v15 offset:8192
  ds_read_b64_tr_b16 v[114:115], v15 offset:8448
  ds_read_b64_tr_b16 v[116:117], v15 offset:8704
  ds_read_b64_tr_b16 v[118:119], v15 offset:8960
  v_exp_f32 v51, v51
  v_cvt_pk_bf16_f32 v96, v48, v49
  v_exp_f32 v52, v52
  v_exp_f32 v53, v53
  v_cvt_pk_bf16_f32 v97, v50, v51
  v_exp_f32 v54, v54
  s_waitcnt lgkmcnt(5)
  v_mfma_f32_32x32x16_bf16 v[32:47], v[104:107], v[8:11], v[64:79]
  v_exp_f32 v55, v55
  v_cvt_pk_bf16_f32 v98, v52, v53
  v_exp_f32 v56, v56
  v_exp_f32 v57, v57
  v_cvt_pk_bf16_f32 v99, v54, v55
  v_exp_f32 v58, v58
  v_exp_f32 v59, v59
  v_mfma_f32_32x32x16_bf16 v[80:95], v[120:123], v[96:99], v[80:95]
  v_cvt_pk_bf16_f32 v100, v56, v57
  v_exp_f32 v60, v60
  v_exp_f32 v61, v61
  v_cvt_pk_bf16_f32 v101, v58, v59
  v_exp_f32 v62, v62
  v_exp_f32 v63, v63
  v_cvt_pk_bf16_f32 v102, v60, v61
  v_add_u32 v14, 8192, v14
  v_add_u32 v15, v21, v15
  s_add_u32 s66, s66, 1
  s_cmp_eq_u32 s66, 6
  s_cbranch_scc0 k2_attn_kernel_nosw
  s_setprio 0
k2_attn_kernel_nosw:
  s_cmp_ge_u32 s66, 3
  s_cselect_b32 s69, 3, 2
  s_cmp_ge_u32 s68, s69
  s_cbranch_scc1 k2_attn_kernel_ok2
k2_attn_kernel_sp2:
  ds_read_b128 v[24:27], v22
  s_waitcnt lgkmcnt(0)
  v_min_u32 v24, v24, v25
  v_min_u32 v26, v26, v27
  v_min_u32 v24, v24, v26
  s_nop 0
  v_readfirstlane_b32 s68, v24
  s_nop 3
  s_cmp_ge_u32 s68, s69
  s_cbranch_scc0 k2_attn_kernel_sp2
k2_attn_kernel_ok2:
  s_cmp_lt_u32 s66, 8
  s_cbranch_scc1 k2_attn_kernel_loop
  v_cvt_pk_bf16_f32 v103, v62, v63
  s_nop 1
  v_mfma_f32_32x32x16_bf16 v[80:95], v[124:127], v[100:103], v[80:95]
  s_waitcnt lgkmcnt(0)
  s_nop 15
  s_nop 7
  v_rcp_f32 v16, v88
  s_nop 0
  v_mul_f32 v16, v16, v7
  v_mul_f32 v80, v80, v16
  v_mul_f32 v81, v81, v16
  v_mul_f32 v82, v82, v16
  v_mul_f32 v83, v83, v16
  v_mul_f32 v84, v84, v16
  v_mul_f32 v85, v85, v16
  v_mul_f32 v86, v86, v16
  v_mul_f32 v87, v87, v16
  v_cvt_pk_bf16_f32 v96, v80, v81
  v_cvt_pk_bf16_f32 v97, v82, v83
  v_cvt_pk_bf16_f32 v98, v84, v85
  v_cvt_pk_bf16_f32 v99, v86, v87
  s_mul_i32 s54, s53, 118
  s_add_u32 s54, s54, s51
  s_lshl_b32 s54, s54, 10
  s_add_u32 s54, s54, 6291456
  buffer_store_dwordx4 v[96:99], v4, s[36:39], s54 offen sc1
  s_endpgm
k2_attn_kernel_gemm:
  s_setprio 3
  s_sub_u32 s49, s48, 8
  s_waitcnt lgkmcnt(0)
  s_mov_b32 s36, s6
  s_and_b32 s37, s7, 0xffff
  s_mov_b32 s38, 33554432
  s_mov_b32 s39, 0x00020000
  s_lshl_b32 s55, s51, 16
  s_lshl_b32 s56, s49, 10
  s_add_u32 s55, s55, s56
  s_lshl_b32 s62, s49, 2
  s_add_u32 s62, s62, 147456
  v_mov_b32 v5, s62
  v_mov_b32 v8, 1
  v_mov_b32 v9, 2
  v_mov_b32 v10, 3
  s_add_u32 m0, s56, 0
  s_add_u32 s57, s55, 2097152
  buffer_load_dwordx4 v4, s[36:39], s57 offen lds
  s_add_u32 m0, s56, 65536
  s_add_u32 s57, s55, 4194304
  buffer_load_dwordx4 v4, s[36:39], s57 offen lds
  s_add_u32 m0, s56, 4096
  s_add_u32 s57, s55, 2101248
  buffer_load_dwordx4 v4, s[36:39], s57 offen lds
  s_add_u32 m0, s56, 69632
  s_add_u32 s57, s55, 4198400
  buffer_load_dwordx4 v4, s[36:39], s57 offen lds
  s_add_u32 m0, s56, 8192
  s_add_u32 s57, s55, 2105344
  buffer_load_dwordx4 v4, s[36:39], s57 offen lds
  s_add_u32 m0, s56, 73728
  s_add_u32 s57, s55, 4202496
  buffer_load_dwordx4 v4, s[36:39], s57 offen lds
  s_barrier
  s_add_u32 m0, s56, 12288
  s_add_u32 s57, s55, 2109440
  buffer_load_dwordx4 v4, s[36:39], s57 offen lds
  s_add_u32 m0, s56, 77824
  s_add_u32 s57, s55, 4206592
  buffer_load_dwordx4 v4, s[36:39], s57 offen lds
  s_add_u32 m0, s56, 16384
  s_add_u32 s57, s55, 2113536
  buffer_load_dwordx4 v4, s[36:39], s57 offen lds
  s_add_u32 m0, s56, 81920
  s_add_u32 s57, s55, 4210688
  buffer_load_dwordx4 v4, s[36:39], s57 offen lds
  s_add_u32 m0, s56, 20480
  s_add_u32 s57, s55, 2117632
  buffer_load_dwordx4 v4, s[36:39], s57 offen lds
  s_add_u32 m0, s56, 86016
  s_add_u32 s57, s55, 4214784
  buffer_load_dwordx4 v4, s[36:39], s57 offen lds
  s_add_u32 m0, s56, 24576
  s_add_u32 s57, s55, 2121728
  buffer_load_dwordx4 v4, s[36:39], s57 offen lds
  s_add_u32 m0, s56, 90112
  s_add_u32 s57, s55, 4218880
  buffer_load_dwordx4 v4, s[36:39], s57 offen lds
  s_waitcnt vmcnt(8)
  ds_write_b32 v5, v8
  s_add_u32 m0, s56, 28672
  s_add_u32 s57, s55, 2125824
  buffer_load_dwordx4 v4, s[36:39], s57 offen lds
  s_add_u32 m0, s56, 94208
  s_add_u32 s57, s55, 4222976
  buffer_load_dwordx4 v4, s[36:39], s57 offen lds
  s_add_u32 m0, s56, 32768
  s_add_u32 s57, s55, 2129920
  buffer_load_dwordx4 v4, s[36:39], s57 offen lds
  s_add_u32 m0, s56, 98304
  s_add_u32 s57, s55, 4227072
  buffer_load_dwordx4 v4, s[36:39], s57 offen lds
  s_add_u32 m0, s56, 36864
  s_add_u32 s57, s55, 2134016
  buffer_load_dwordx4 v4, s[36:39], s57 offen lds
  s_add_u32 m0, s56, 102400
  s_add_u32 s57, s55, 4231168
  buffer_load_dwordx4 v4, s[36:39], s57 offen lds
  s_add_u32 m0, s56, 40960
  s_add_u32 s57, s55, 2138112
  buffer_load_dwordx4 v4, s[36:39], s57 offen lds
  s_add_u32 m0, s56, 106496
  s_add_u32 s57, s55, 4235264
  buffer_load_dwordx4 v4, s[36:39], s57 offen lds
  s_add_u32 m0, s56, 45056
  s_add_u32 s57, s55, 2142208
  buffer_load_dwordx4 v4, s[36:39], s57 offen lds
  s_add_u32 m0, s56, 110592
  s_add_u32 s57, s55, 4239360
  buffer_load_dwordx4 v4, s[36:39], s57 offen lds
  s_add_u32 m0, s56, 49152
  s_add_u32 s57, s55, 2146304
  buffer_load_dwordx4 v4, s[36:39], s57 offen lds
  s_add_u32 m0, s56, 114688
  s_add_u32 s57, s55, 4243456
  buffer_load_dwordx4 v4, s[36:39], s57 offen lds
  s_waitcnt vmcnt(12)
  ds_write_b32 v5, v9
  s_add_u32 m0, s56, 53248
  s_add_u32 s57, s55, 2150400
  buffer_load_dwordx4 v4, s[36:39], s57 offen lds
  s_add_u32 m0, s56, 118784
  s_add_u32 s57, s55, 4247552
  buffer_load_dwordx4 v4, s[36:39], s57 offen lds
  s_add_u32 m0, s56, 57344
  s_add_u32 s57, s55, 2154496
  buffer_load_dwordx4 v4, s[36:39], s57 offen lds
  s_add_u32 m0, s56, 122880
  s_add_u32 s57, s55, 4251648
  buffer_load_dwordx4 v4, s[36:39], s57 offen lds
  s_add_u32 m0, s56, 61440
  s_add_u32 s57, s55, 2158592
  buffer_load_dwordx4 v4, s[36:39], s57 offen lds
  s_add_u32 m0, s56, 126976
  s_add_u32 s57, s55, 4255744
  buffer_load_dwordx4 v4, s[36:39], s57 offen lds
  s_and_b32 s58, s2, 7
  s_lshl_b32 s58, s58, 3
  s_lshr_b32 s59, s50, 3
  s_lshl_b32 s59, s59, 1
  s_add_u32 s58, s58, s59
  s_lshr_b32 s59, s49, 1
  s_add_u32 s58, s58, s59
  s_and_b32 s59, s50, 7
  s_lshl_b32 s59, s59, 1
  s_and_b32 s60, s49, 1
  s_add_u32 s59, s59, s60
  s_mul_i32 s60, s58, 118
  s_add_u32 s60, s60, 32
  s_lshl_b32 s60, s60, 10
  s_add_u32 s60, s60, 6291456
  s_mul_i32 s61, s59, 118
  s_add_u32 s61, s61, 32
  s_lshl_b32 s61, s61, 10
  s_add_u32 s61, s61, 17825792
  s_waitcnt vmcnt(0)
  ds_write_b32 v5, v10
  v_mov_b32 v16, 0
  v_mov_b32 v17, 0
  v_mov_b32 v18, 0
  v_mov_b32 v19, 0
  v_mov_b32 v20, 0
  v_mov_b32 v21, 0
  v_mov_b32 v22, 0
  v_mov_b32 v23, 0
  v_mov_b32 v24, 0
  v_mov_b32 v25, 0
  v_mov_b32 v26, 0
  v_mov_b32 v27, 0
  v_mov_b32 v28, 0
  v_mov_b32 v29, 0
  v_mov_b32 v30, 0
  v_mov_b32 v31, 0
  v_and_b32 v5, 31, v1
  v_lshlrev_b32 v5, 2, v5
  s_lshl_b32 s54, s58, 7
  s_add_u32 s54, s54, 19922944
  buffer_load_dword v7, v5, s[36:39], s54 offen
  buffer_load_dwordx4 v[32:35], v4, s[36:39], s61 offen
  buffer_load_dwordx4 v[36:39], v4, s[36:39], s60 offen
  s_add_u32 s61, s61, 1024
  s_add_u32 s60, s60, 1024
  buffer_load_dwordx4 v[40:43], v4, s[36:39], s61 offen
  buffer_load_dwordx4 v[44:47], v4, s[36:39], s60 offen
  s_add_u32 s61, s61, 1024
  s_add_u32 s60, s60, 1024
  buffer_load_dwordx4 v[48:51], v4, s[36:39], s61 offen
  buffer_load_dwordx4 v[52:55], v4, s[36:39], s60 offen
  s_add_u32 s61, s61, 1024
  s_add_u32 s60, s60, 1024
  buffer_load_dwordx4 v[56:59], v4, s[36:39], s61 offen
  buffer_load_dwordx4 v[60:63], v4, s[36:39], s60 offen
  s_add_u32 s61, s61, 1024
  s_add_u32 s60, s60, 1024
  buffer_load_dwordx4 v[64:67], v4, s[36:39], s61 offen
  buffer_load_dwordx4 v[68:71], v4, s[36:39], s60 offen
  s_add_u32 s61, s61, 1024
  s_add_u32 s60, s60, 1024
  buffer_load_dwordx4 v[72:75], v4, s[36:39], s61 offen
  buffer_load_dwordx4 v[76:79], v4, s[36:39], s60 offen
  s_add_u32 s61, s61, 1024
  s_add_u32 s60, s60, 1024
  buffer_load_dwordx4 v[80:83], v4, s[36:39], s61 offen
  buffer_load_dwordx4 v[84:87], v4, s[36:39], s60 offen
  s_add_u32 s61, s61, 1024
  s_add_u32 s60, s60, 1024
  buffer_load_dwordx4 v[88:91], v4, s[36:39], s61 offen
  buffer_load_dwordx4 v[92:95], v4, s[36:39], s60 offen
  s_add_u32 s61, s61, 1024
  s_add_u32 s60, s60, 1024
  buffer_load_dwordx4 v[96:99], v4, s[36:39], s61 offen
  buffer_load_dwordx4 v[100:103], v4, s[36:39], s60 offen
  s_add_u32 s61, s61, 1024
  s_add_u32 s60, s60, 1024
  buffer_load_dwordx4 v[104:107], v4, s[36:39], s61 offen
  buffer_load_dwordx4 v[108:111], v4, s[36:39], s60 offen
  s_add_u32 s61, s61, 1024
  s_add_u32 s60, s60, 1024
  buffer_load_dwordx4 v[112:115], v4, s[36:39], s61 offen
  buffer_load_dwordx4 v[116:119], v4, s[36:39], s60 offen
  s_add_u32 s61, s61, 1024
  s_add_u32 s60, s60, 1024
  buffer_load_dwordx4 v[120:123], v4, s[36:39], s61 offen
  buffer_load_dwordx4 v[124:127], v4, s[36:39], s60 offen
  s_add_u32 s61, s61, 1024
  s_add_u32 s60, s60, 1024
  buffer_load_dwordx4 v[128:131], v4, s[36:39], s61 offen
  buffer_load_dwordx4 v[132:135], v4, s[36:39], s60 offen
  s_add_u32 s61, s61, 1024
  s_add_u32 s60, s60, 1024
  buffer_load_dwordx4 v[136:139], v4, s[36:39], s61 offen
  buffer_load_dwordx4 v[140:143], v4, s[36:39], s60 offen
  s_add_u32 s61, s61, 1024
  s_add_u32 s60, s60, 1024
  buffer_load_dwordx4 v[144:147], v4, s[36:39], s61 offen
  buffer_load_dwordx4 v[148:151], v4, s[36:39], s60 offen
  s_add_u32 s61, s61, 1024
  s_add_u32 s60, s60, 1024
  buffer_load_dwordx4 v[152:155], v4, s[36:39], s61 offen
  buffer_load_dwordx4 v[156:159], v4, s[36:39], s60 offen
  s_add_u32 s61, s61, 1024
  s_add_u32 s60, s60, 1024
  s_waitcnt vmcnt(30)
  v_mfma_f32_32x32x16_bf16 v[16:31], v[32:35], v[36:39], v[16:31]
  buffer_load_dwordx4 v[32:35], v4, s[36:39], s61 offen
  buffer_load_dwordx4 v[36:39], v4, s[36:39], s60 offen
  s_add_u32 s61, s61, 1024
  s_add_u32 s60, s60, 1024
  s_waitcnt vmcnt(30)
  v_mfma_f32_32x32x16_bf16 v[16:31], v[40:43], v[44:47], v[16:31]
  buffer_load_dwordx4 v[40:43], v4, s[36:39], s61 offen
  buffer_load_dwordx4 v[44:47], v4, s[36:39], s60 offen
  s_add_u32 s61, s61, 1024
  s_add_u32 s60, s60, 1024
  s_waitcnt vmcnt(30)
  v_mfma_f32_32x32x16_bf16 v[16:31], v[48:51], v[52:55], v[16:31]
  buffer_load_dwordx4 v[48:51], v4, s[36:39], s61 offen
  buffer_load_dwordx4 v[52:55], v4, s[36:39], s60 offen
  s_add_u32 s61, s61, 1024
  s_add_u32 s60, s60, 1024
  s_waitcnt vmcnt(30)
  v_mfma_f32_32x32x16_bf16 v[16:31], v[56:59], v[60:63], v[16:31]
  buffer_load_dwordx4 v[56:59], v4, s[36:39], s61 offen
  buffer_load_dwordx4 v[60:63], v4, s[36:39], s60 offen
  s_add_u32 s61, s61, 1024
  s_add_u32 s60, s60, 1024
  s_waitcnt vmcnt(30)
  v_mfma_f32_32x32x16_bf16 v[16:31], v[64:67], v[68:71], v[16:31]
  buffer_load_dwordx4 v[64:67], v4, s[36:39], s61 offen
  buffer_load_dwordx4 v[68:71], v4, s[36:39], s60 offen
  s_add_u32 s61, s61, 1024
  s_add_u32 s60, s60, 1024
  s_waitcnt vmcnt(30)
  v_mfma_f32_32x32x16_bf16 v[16:31], v[72:75], v[76:79], v[16:31]
  buffer_load_dwordx4 v[72:75], v4, s[36:39], s61 offen
  buffer_load_dwordx4 v[76:79], v4, s[36:39], s60 offen
  s_add_u32 s61, s61, 1024
  s_add_u32 s60, s60, 1024
  s_waitcnt vmcnt(30)
  v_mfma_f32_32x32x16_bf16 v[16:31], v[80:83], v[84:87], v[16:31]
  buffer_load_dwordx4 v[80:83], v4, s[36:39], s61 offen
  buffer_load_dwordx4 v[84:87], v4, s[36:39], s60 offen
  s_add_u32 s61, s61, 1024
  s_add_u32 s60, s60, 1024
  s_waitcnt vmcnt(30)
  v_mfma_f32_32x32x16_bf16 v[16:31], v[88:91], v[92:95], v[16:31]
  buffer_load_dwordx4 v[88:91], v4, s[36:39], s61 offen
  buffer_load_dwordx4 v[92:95], v4, s[36:39], s60 offen
  s_add_u32 s61, s61, 1024
  s_add_u32 s60, s60, 1024
  s_waitcnt vmcnt(30)
  v_mfma_f32_32x32x16_bf16 v[16:31], v[96:99], v[100:103], v[16:31]
  buffer_load_dwordx4 v[96:99], v4, s[36:39], s61 offen
  buffer_load_dwordx4 v[100:103], v4, s[36:39], s60 offen
  s_add_u32 s61, s61, 1024
  s_add_u32 s60, s60, 1024
  s_waitcnt vmcnt(30)
  v_mfma_f32_32x32x16_bf16 v[16:31], v[104:107], v[108:111], v[16:31]
  buffer_load_dwordx4 v[104:107], v4, s[36:39], s61 offen
  buffer_load_dwordx4 v[108:111], v4, s[36:39], s60 offen
  s_add_u32 s61, s61, 1024
  s_add_u32 s60, s60, 1024
  s_waitcnt vmcnt(30)
  v_mfma_f32_32x32x16_bf16 v[16:31], v[112:115], v[116:119], v[16:31]
  buffer_load_dwordx4 v[112:115], v4, s[36:39], s61 offen
  buffer_load_dwordx4 v[116:119], v4, s[36:39], s60 offen
  s_add_u32 s61, s61, 1024
  s_add_u32 s60, s60, 1024
  s_waitcnt vmcnt(30)
  v_mfma_f32_32x32x16_bf16 v[16:31], v[120:123], v[124:127], v[16:31]
  buffer_load_dwordx4 v[120:123], v4, s[36:39], s61 offen
  buffer_load_dwordx4 v[124:127], v4, s[36:39], s60 offen
  s_add_u32 s61, s61, 1024
  s_add_u32 s60, s60, 1024
  s_waitcnt vmcnt(30)
  v_mfma_f32_32x32x16_bf16 v[16:31], v[128:131], v[132:135], v[16:31]
  buffer_load_dwordx4 v[128:131], v4, s[36:39], s61 offen
  buffer_load_dwordx4 v[132:135], v4, s[36:39], s60 offen
  s_add_u32 s61, s61, 1024
  s_add_u32 s60, s60, 1024
  s_waitcnt vmcnt(30)
  v_mfma_f32_32x32x16_bf16 v[16:31], v[136:139], v[140:143], v[16:31]
  buffer_load_dwordx4 v[136:139], v4, s[36:39], s61 offen
  buffer_load_dwordx4 v[140:143], v4, s[36:39], s60 offen
  s_add_u32 s61, s61, 1024
  s_add_u32 s60, s60, 1024
  s_waitcnt vmcnt(30)
  v_mfma_f32_32x32x16_bf16 v[16:31], v[144:147], v[148:151], v[16:31]
  buffer_load_dwordx4 v[144:147], v4, s[36:39], s61 offen
  buffer_load_dwordx4 v[148:151], v4, s[36:39], s60 offen
  s_add_u32 s61, s61, 1024
  s_add_u32 s60, s60, 1024
  s_waitcnt vmcnt(30)
  v_mfma_f32_32x32x16_bf16 v[16:31], v[152:155], v[156:159], v[16:31]
  buffer_load_dwordx4 v[152:155], v4, s[36:39], s61 offen
  buffer_load_dwordx4 v[156:159], v4, s[36:39], s60 offen
  s_add_u32 s61, s61, 1024
  s_add_u32 s60, s60, 1024
  s_waitcnt vmcnt(30)
  v_mfma_f32_32x32x16_bf16 v[16:31], v[32:35], v[36:39], v[16:31]
  buffer_load_dwordx4 v[32:35], v4, s[36:39], s61 offen
  buffer_load_dwordx4 v[36:39], v4, s[36:39], s60 offen
  s_add_u32 s61, s61, 1024
  s_add_u32 s60, s60, 1024
  s_waitcnt vmcnt(30)
  v_mfma_f32_32x32x16_bf16 v[16:31], v[40:43], v[44:47], v[16:31]
  buffer_load_dwordx4 v[40:43], v4, s[36:39], s61 offen
  buffer_load_dwordx4 v[44:47], v4, s[36:39], s60 offen
  s_add_u32 s61, s61, 1024
  s_add_u32 s60, s60, 1024
  s_waitcnt vmcnt(30)
  v_mfma_f32_32x32x16_bf16 v[16:31], v[48:51], v[52:55], v[16:31]
  buffer_load_dwordx4 v[48:51], v4, s[36:39], s61 offen
  buffer_load_dwordx4 v[52:55], v4, s[36:39], s60 offen
  s_add_u32 s61, s61, 1024
  s_add_u32 s60, s60, 1024
  s_waitcnt vmcnt(30)
  v_mfma_f32_32x32x16_bf16 v[16:31], v[56:59], v[60:63], v[16:31]
  buffer_load_dwordx4 v[56:59], v4, s[36:39], s61 offen
  buffer_load_dwordx4 v[60:63], v4, s[36:39], s60 offen
  s_add_u32 s61, s61, 1024
  s_add_u32 s60, s60, 1024
  s_waitcnt vmcnt(30)
  v_mfma_f32_32x32x16_bf16 v[16:31], v[64:67], v[68:71], v[16:31]
  buffer_load_dwordx4 v[64:67], v4, s[36:39], s61 offen
  buffer_load_dwordx4 v[68:71], v4, s[36:39], s60 offen
  s_add_u32 s61, s61, 1024
  s_add_u32 s60, s60, 1024
  s_waitcnt vmcnt(30)
  v_mfma_f32_32x32x16_bf16 v[16:31], v[72:75], v[76:79], v[16:31]
  buffer_load_dwordx4 v[72:75], v4, s[36:39], s61 offen
  buffer_load_dwordx4 v[76:79], v4, s[36:39], s60 offen
  s_add_u32 s61, s61, 1024
  s_add_u32 s60, s60, 1024
  s_waitcnt vmcnt(30)
  v_mfma_f32_32x32x16_bf16 v[16:31], v[80:83], v[84:87], v[16:31]
  buffer_load_dwordx4 v[80:83], v4, s[36:39], s61 offen
  buffer_load_dwordx4 v[84:87], v4, s[36:39], s60 offen
  s_add_u32 s61, s61, 1024
  s_add_u32 s60, s60, 1024
  s_waitcnt vmcnt(30)
  v_mfma_f32_32x32x16_bf16 v[16:31], v[88:91], v[92:95], v[16:31]
  buffer_load_dwordx4 v[88:91], v4, s[36:39], s61 offen
  buffer_load_dwordx4 v[92:95], v4, s[36:39], s60 offen
  s_add_u32 s61, s61, 1024
  s_add_u32 s60, s60, 1024
  s_waitcnt vmcnt(30)
  v_mfma_f32_32x32x16_bf16 v[16:31], v[96:99], v[100:103], v[16:31]
  buffer_load_dwordx4 v[96:99], v4, s[36:39], s61 offen
  buffer_load_dwordx4 v[100:103], v4, s[36:39], s60 offen
  s_add_u32 s61, s61, 1024
  s_add_u32 s60, s60, 1024
  s_waitcnt vmcnt(30)
  v_mfma_f32_32x32x16_bf16 v[16:31], v[104:107], v[108:111], v[16:31]
  buffer_load_dwordx4 v[104:107], v4, s[36:39], s61 offen
  buffer_load_dwordx4 v[108:111], v4, s[36:39], s60 offen
  s_add_u32 s61, s61, 1024
  s_add_u32 s60, s60, 1024
  s_waitcnt vmcnt(30)
  v_mfma_f32_32x32x16_bf16 v[16:31], v[112:115], v[116:119], v[16:31]
  buffer_load_dwordx4 v[112:115], v4, s[36:39], s61 offen
  buffer_load_dwordx4 v[116:119], v4, s[36:39], s60 offen
  s_add_u32 s61, s61, 1024
  s_add_u32 s60, s60, 1024
  s_waitcnt vmcnt(30)
  v_mfma_f32_32x32x16_bf16 v[16:31], v[120:123], v[124:127], v[16:31]
  buffer_load_dwordx4 v[120:123], v4, s[36:39], s61 offen
  buffer_load_dwordx4 v[124:127], v4, s[36:39], s60 offen
  s_add_u32 s61, s61, 1024
  s_add_u32 s60, s60, 1024
  s_waitcnt vmcnt(30)
  v_mfma_f32_32x32x16_bf16 v[16:31], v[128:131], v[132:135], v[16:31]
  buffer_load_dwordx4 v[128:131], v4, s[36:39], s61 offen
  buffer_load_dwordx4 v[132:135], v4, s[36:39], s60 offen
  s_add_u32 s61, s61, 1024
  s_add_u32 s60, s60, 1024
  s_waitcnt vmcnt(30)
  v_mfma_f32_32x32x16_bf16 v[16:31], v[136:139], v[140:143], v[16:31]
  buffer_load_dwordx4 v[136:139], v4, s[36:39], s61 offen
  buffer_load_dwordx4 v[140:143], v4, s[36:39], s60 offen
  s_add_u32 s61, s61, 1024
  s_add_u32 s60, s60, 1024
  s_waitcnt vmcnt(30)
  v_mfma_f32_32x32x16_bf16 v[16:31], v[144:147], v[148:151], v[16:31]
  buffer_load_dwordx4 v[144:147], v4, s[36:39], s61 offen
  buffer_load_dwordx4 v[148:151], v4, s[36:39], s60 offen
  s_add_u32 s61, s61, 1024
  s_add_u32 s60, s60, 1024
  s_waitcnt vmcnt(30)
  v_mfma_f32_32x32x16_bf16 v[16:31], v[152:155], v[156:159], v[16:31]
  buffer_load_dwordx4 v[152:155], v4, s[36:39], s61 offen
  buffer_load_dwordx4 v[156:159], v4, s[36:39], s60 offen
  s_add_u32 s61, s61, 1024
  s_add_u32 s60, s60, 1024
  s_waitcnt vmcnt(30)
  v_mfma_f32_32x32x16_bf16 v[16:31], v[32:35], v[36:39], v[16:31]
  buffer_load_dwordx4 v[32:35], v4, s[36:39], s61 offen
  buffer_load_dwordx4 v[36:39], v4, s[36:39], s60 offen
  s_add_u32 s61, s61, 1024
  s_add_u32 s60, s60, 1024
  s_waitcnt vmcnt(30)
  v_mfma_f32_32x32x16_bf16 v[16:31], v[40:43], v[44:47], v[16:31]
  buffer_load_dwordx4 v[40:43], v4, s[36:39], s61 offen
  buffer_load_dwordx4 v[44:47], v4, s[36:39], s60 offen
  s_add_u32 s61, s61, 1024
  s_add_u32 s60, s60, 1024
  s_waitcnt vmcnt(30)
  v_mfma_f32_32x32x16_bf16 v[16:31], v[48:51], v[52:55], v[16:31]
  buffer_load_dwordx4 v[48:51], v4, s[36:39], s61 offen
  buffer_load_dwordx4 v[52:55], v4, s[36:39], s60 offen
  s_add_u32 s61, s61, 1024
  s_add_u32 s60, s60, 1024
  s_waitcnt vmcnt(30)
  v_mfma_f32_32x32x16_bf16 v[16:31], v[56:59], v[60:63], v[16:31]
  buffer_load_dwordx4 v[56:59], v4, s[36:39], s61 offen
  buffer_load_dwordx4 v[60:63], v4, s[36:39], s60 offen
  s_add_u32 s61, s61, 1024
  s_add_u32 s60, s60, 1024
  s_waitcnt vmcnt(30)
  v_mfma_f32_32x32x16_bf16 v[16:31], v[64:67], v[68:71], v[16:31]
  buffer_load_dwordx4 v[64:67], v4, s[36:39], s61 offen
  buffer_load_dwordx4 v[68:71], v4, s[36:39], s60 offen
  s_add_u32 s61, s61, 1024
  s_add_u32 s60, s60, 1024
  s_waitcnt vmcnt(30)
  v_mfma_f32_32x32x16_bf16 v[16:31], v[72:75], v[76:79], v[16:31]
  buffer_load_dwordx4 v[72:75], v4, s[36:39], s61 offen
  buffer_load_dwordx4 v[76:79], v4, s[36:39], s60 offen
  s_add_u32 s61, s61, 1024
  s_add_u32 s60, s60, 1024
  s_waitcnt vmcnt(30)
  v_mfma_f32_32x32x16_bf16 v[16:31], v[80:83], v[84:87], v[16:31]
  buffer_load_dwordx4 v[80:83], v4, s[36:39], s61 offen
  buffer_load_dwordx4 v[84:87], v4, s[36:39], s60 offen
  s_add_u32 s61, s61, 1024
  s_add_u32 s60, s60, 1024
  s_waitcnt vmcnt(30)
  v_mfma_f32_32x32x16_bf16 v[16:31], v[88:91], v[92:95], v[16:31]
  buffer_load_dwordx4 v[88:91], v4, s[36:39], s61 offen
  buffer_load_dwordx4 v[92:95], v4, s[36:39], s60 offen
  s_add_u32 s61, s61, 1024
  s_add_u32 s60, s60, 1024
  s_waitcnt vmcnt(30)
  v_mfma_f32_32x32x16_bf16 v[16:31], v[96:99], v[100:103], v[16:31]
  buffer_load_dwordx4 v[96:99], v4, s[36:39], s61 offen
  buffer_load_dwordx4 v[100:103], v4, s[36:39], s60 offen
  s_add_u32 s61, s61, 1024
  s_add_u32 s60, s60, 1024
  s_waitcnt vmcnt(30)
  v_mfma_f32_32x32x16_bf16 v[16:31], v[104:107], v[108:111], v[16:31]
  buffer_load_dwordx4 v[104:107], v4, s[36:39], s61 offen
  buffer_load_dwordx4 v[108:111], v4, s[36:39], s60 offen
  s_add_u32 s61, s61, 1024
  s_add_u32 s60, s60, 1024
  s_waitcnt vmcnt(30)
  v_mfma_f32_32x32x16_bf16 v[16:31], v[112:115], v[116:119], v[16:31]
  buffer_load_dwordx4 v[112:115], v4, s[36:39], s61 offen
  buffer_load_dwordx4 v[116:119], v4, s[36:39], s60 offen
  s_add_u32 s61, s61, 1024
  s_add_u32 s60, s60, 1024
  s_waitcnt vmcnt(30)
  v_mfma_f32_32x32x16_bf16 v[16:31], v[120:123], v[124:127], v[16:31]
  buffer_load_dwordx4 v[120:123], v4, s[36:39], s61 offen
  buffer_load_dwordx4 v[124:127], v4, s[36:39], s60 offen
  s_add_u32 s61, s61, 1024
  s_add_u32 s60, s60, 1024
  s_waitcnt vmcnt(30)
  v_mfma_f32_32x32x16_bf16 v[16:31], v[128:131], v[132:135], v[16:31]
  buffer_load_dwordx4 v[128:131], v4, s[36:39], s61 offen
  buffer_load_dwordx4 v[132:135], v4, s[36:39], s60 offen
  s_add_u32 s61, s61, 1024
  s_add_u32 s60, s60, 1024
  s_waitcnt vmcnt(30)
  v_mfma_f32_32x32x16_bf16 v[16:31], v[136:139], v[140:143], v[16:31]
  buffer_load_dwordx4 v[136:139], v4, s[36:39], s61 offen
  buffer_load_dwordx4 v[140:143], v4, s[36:39], s60 offen
  s_add_u32 s61, s61, 1024
  s_add_u32 s60, s60, 1024
  s_waitcnt vmcnt(30)
  v_mfma_f32_32x32x16_bf16 v[16:31], v[144:147], v[148:151], v[16:31]
  buffer_load_dwordx4 v[144:147], v4, s[36:39], s61 offen
  buffer_load_dwordx4 v[148:151], v4, s[36:39], s60 offen
  s_add_u32 s61, s61, 1024
  s_add_u32 s60, s60, 1024
  s_waitcnt vmcnt(30)
  v_mfma_f32_32x32x16_bf16 v[16:31], v[152:155], v[156:159], v[16:31]
  buffer_load_dwordx4 v[152:155], v4, s[36:39], s61 offen
  buffer_load_dwordx4 v[156:159], v4, s[36:39], s60 offen
  s_add_u32 s61, s61, 1024
  s_add_u32 s60, s60, 1024
  s_waitcnt vmcnt(30)
  v_mfma_f32_32x32x16_bf16 v[16:31], v[32:35], v[36:39], v[16:31]
  buffer_load_dwordx4 v[32:35], v4, s[36:39], s61 offen
  buffer_load_dwordx4 v[36:39], v4, s[36:39], s60 offen
  s_add_u32 s61, s61, 1024
  s_add_u32 s60, s60, 1024
  s_waitcnt vmcnt(30)
  v_mfma_f32_32x32x16_bf16 v[16:31], v[40:43], v[44:47], v[16:31]
  buffer_load_dwordx4 v[40:43], v4, s[36:39], s61 offen
  buffer_load_dwordx4 v[44:47], v4, s[36:39], s60 offen
  s_add_u32 s61, s61, 1024
  s_add_u32 s60, s60, 1024
  s_waitcnt vmcnt(30)
  v_mfma_f32_32x32x16_bf16 v[16:31], v[48:51], v[52:55], v[16:31]
  buffer_load_dwordx4 v[48:51], v4, s[36:39], s61 offen
  buffer_load_dwordx4 v[52:55], v4, s[36:39], s60 offen
  s_add_u32 s61, s61, 1024
  s_add_u32 s60, s60, 1024
  s_waitcnt vmcnt(30)
  v_mfma_f32_32x32x16_bf16 v[16:31], v[56:59], v[60:63], v[16:31]
  buffer_load_dwordx4 v[56:59], v4, s[36:39], s61 offen
  buffer_load_dwordx4 v[60:63], v4, s[36:39], s60 offen
  s_add_u32 s61, s61, 1024
  s_add_u32 s60, s60, 1024
  s_waitcnt vmcnt(30)
  v_mfma_f32_32x32x16_bf16 v[16:31], v[64:67], v[68:71], v[16:31]
  buffer_load_dwordx4 v[64:67], v4, s[36:39], s61 offen
  buffer_load_dwordx4 v[68:71], v4, s[36:39], s60 offen
  s_add_u32 s61, s61, 1024
  s_add_u32 s60, s60, 1024
  s_waitcnt vmcnt(30)
  v_mfma_f32_32x32x16_bf16 v[16:31], v[72:75], v[76:79], v[16:31]
  buffer_load_dwordx4 v[72:75], v4, s[36:39], s61 offen
  buffer_load_dwordx4 v[76:79], v4, s[36:39], s60 offen
  s_add_u32 s61, s61, 1024
  s_add_u32 s60, s60, 1024
  s_waitcnt vmcnt(30)
  v_mfma_f32_32x32x16_bf16 v[16:31], v[80:83], v[84:87], v[16:31]
  buffer_load_dwordx4 v[80:83], v4, s[36:39], s61 offen
  buffer_load_dwordx4 v[84:87], v4, s[36:39], s60 offen
  s_add_u32 s61, s61, 1024
  s_add_u32 s60, s60, 1024
  s_waitcnt vmcnt(30)
  v_mfma_f32_32x32x16_bf16 v[16:31], v[88:91], v[92:95], v[16:31]
  buffer_load_dwordx4 v[88:91], v4, s[36:39], s61 offen
  buffer_load_dwordx4 v[92:95], v4, s[36:39], s60 offen
  s_add_u32 s61, s61, 1024
  s_add_u32 s60, s60, 1024
  s_waitcnt vmcnt(30)
  v_mfma_f32_32x32x16_bf16 v[16:31], v[96:99], v[100:103], v[16:31]
  buffer_load_dwordx4 v[96:99], v4, s[36:39], s61 offen
  buffer_load_dwordx4 v[100:103], v4, s[36:39], s60 offen
  s_add_u32 s61, s61, 1024
  s_add_u32 s60, s60, 1024
  s_waitcnt vmcnt(30)
  v_mfma_f32_32x32x16_bf16 v[16:31], v[104:107], v[108:111], v[16:31]
  buffer_load_dwordx4 v[104:107], v4, s[36:39], s61 offen
  buffer_load_dwordx4 v[108:111], v4, s[36:39], s60 offen
  s_add_u32 s61, s61, 1024
  s_add_u32 s60, s60, 1024
  s_waitcnt vmcnt(30)
  v_mfma_f32_32x32x16_bf16 v[16:31], v[112:115], v[116:119], v[16:31]
  buffer_load_dwordx4 v[112:115], v4, s[36:39], s61 offen
  buffer_load_dwordx4 v[116:119], v4, s[36:39], s60 offen
  s_add_u32 s61, s61, 1024
  s_add_u32 s60, s60, 1024
  s_waitcnt vmcnt(30)
  v_mfma_f32_32x32x16_bf16 v[16:31], v[120:123], v[124:127], v[16:31]
  buffer_load_dwordx4 v[120:123], v4, s[36:39], s61 offen
  buffer_load_dwordx4 v[124:127], v4, s[36:39], s60 offen
  s_add_u32 s61, s61, 1024
  s_add_u32 s60, s60, 1024
  s_waitcnt vmcnt(30)
  v_mfma_f32_32x32x16_bf16 v[16:31], v[128:131], v[132:135], v[16:31]
  buffer_load_dwordx4 v[128:131], v4, s[36:39], s61 offen
  buffer_load_dwordx4 v[132:135], v4, s[36:39], s60 offen
  s_add_u32 s61, s61, 1024
  s_add_u32 s60, s60, 1024
  s_waitcnt vmcnt(30)
  v_mfma_f32_32x32x16_bf16 v[16:31], v[136:139], v[140:143], v[16:31]
  buffer_load_dwordx4 v[136:139], v4, s[36:39], s61 offen
  buffer_load_dwordx4 v[140:143], v4, s[36:39], s60 offen
  s_add_u32 s61, s61, 1024
  s_add_u32 s60, s60, 1024
  s_waitcnt vmcnt(30)
  v_mfma_f32_32x32x16_bf16 v[16:31], v[144:147], v[148:151], v[16:31]
  buffer_load_dwordx4 v[144:147], v4, s[36:39], s61 offen
  buffer_load_dwordx4 v[148:151], v4, s[36:39], s60 offen
  s_add_u32 s61, s61, 1024
  s_add_u32 s60, s60, 1024
  s_waitcnt vmcnt(30)
  v_mfma_f32_32x32x16_bf16 v[16:31], v[152:155], v[156:159], v[16:31]
  buffer_load_dwordx4 v[152:155], v4, s[36:39], s61 offen
  buffer_load_dwordx4 v[156:159], v4, s[36:39], s60 offen
  s_add_u32 s61, s61, 1024
  s_add_u32 s60, s60, 1024
  s_waitcnt vmcnt(30)
  v_mfma_f32_32x32x16_bf16 v[16:31], v[32:35], v[36:39], v[16:31]
  buffer_load_dwordx4 v[32:35], v4, s[36:39], s61 offen
  buffer_load_dwordx4 v[36:39], v4, s[36:39], s60 offen
  s_add_u32 s61, s61, 1024
  s_add_u32 s60, s60, 1024
  s_waitcnt vmcnt(30)
  v_mfma_f32_32x32x16_bf16 v[16:31], v[40:43], v[44:47], v[16:31]
  buffer_load_dwordx4 v[40:43], v4, s[36:39], s61 offen
  buffer_load_dwordx4 v[44:47], v4, s[36:39], s60 offen
  s_add_u32 s61, s61, 1024
  s_add_u32 s60, s60, 1024
  s_waitcnt vmcnt(30)
  v_mfma_f32_32x32x16_bf16 v[16:31], v[48:51], v[52:55], v[16:31]
  buffer_load_dwordx4 v[48:51], v4, s[36:39], s61 offen
  buffer_load_dwordx4 v[52:55], v4, s[36:39], s60 offen
  s_add_u32 s61, s61, 1024
  s_add_u32 s60, s60, 1024
  s_waitcnt vmcnt(30)
  v_mfma_f32_32x32x16_bf16 v[16:31], v[56:59], v[60:63], v[16:31]
  buffer_load_dwordx4 v[56:59], v4, s[36:39], s61 offen
  buffer_load_dwordx4 v[60:63], v4, s[36:39], s60 offen
  s_add_u32 s61, s61, 1024
  s_add_u32 s60, s60, 1024
  s_waitcnt vmcnt(30)
  v_mfma_f32_32x32x16_bf16 v[16:31], v[64:67], v[68:71], v[16:31]
  buffer_load_dwordx4 v[64:67], v4, s[36:39], s61 offen
  buffer_load_dwordx4 v[68:71], v4, s[36:39], s60 offen
  s_add_u32 s61, s61, 1024
  s_add_u32 s60, s60, 1024
  s_waitcnt vmcnt(30)
  v_mfma_f32_32x32x16_bf16 v[16:31], v[72:75], v[76:79], v[16:31]
  buffer_load_dwordx4 v[72:75], v4, s[36:39], s61 offen
  buffer_load_dwordx4 v[76:79], v4, s[36:39], s60 offen
  s_add_u32 s61, s61, 1024
  s_add_u32 s60, s60, 1024
  s_waitcnt vmcnt(30)
  v_mfma_f32_32x32x16_bf16 v[16:31], v[80:83], v[84:87], v[16:31]
  s_waitcnt vmcnt(28)
  v_mfma_f32_32x32x16_bf16 v[16:31], v[88:91], v[92:95], v[16:31]
  s_waitcnt vmcnt(26)
  v_mfma_f32_32x32x16_bf16 v[16:31], v[96:99], v[100:103], v[16:31]
  s_waitcnt vmcnt(24)
  v_mfma_f32_32x32x16_bf16 v[16:31], v[104:107], v[108:111], v[16:31]
  s_waitcnt vmcnt(22)
  v_mfma_f32_32x32x16_bf16 v[16:31], v[112:115], v[116:119], v[16:31]
  s_waitcnt vmcnt(20)
  v_mfma_f32_32x32x16_bf16 v[16:31], v[120:123], v[124:127], v[16:31]
  s_waitcnt vmcnt(18)
  v_mfma_f32_32x32x16_bf16 v[16:31], v[128:131], v[132:135], v[16:31]
  s_waitcnt vmcnt(16)
  v_mfma_f32_32x32x16_bf16 v[16:31], v[136:139], v[140:143], v[16:31]
  s_waitcnt vmcnt(14)
  v_mfma_f32_32x32x16_bf16 v[16:31], v[144:147], v[148:151], v[16:31]
  s_waitcnt vmcnt(12)
  v_mfma_f32_32x32x16_bf16 v[16:31], v[152:155], v[156:159], v[16:31]
  s_waitcnt vmcnt(10)
  v_mfma_f32_32x32x16_bf16 v[16:31], v[32:35], v[36:39], v[16:31]
  s_waitcnt vmcnt(8)
  v_mfma_f32_32x32x16_bf16 v[16:31], v[40:43], v[44:47], v[16:31]
  s_waitcnt vmcnt(6)
  v_mfma_f32_32x32x16_bf16 v[16:31], v[48:51], v[52:55], v[16:31]
  s_waitcnt vmcnt(4)
  v_mfma_f32_32x32x16_bf16 v[16:31], v[56:59], v[60:63], v[16:31]
  s_waitcnt vmcnt(2)
  v_mfma_f32_32x32x16_bf16 v[16:31], v[64:67], v[68:71], v[16:31]
  s_waitcnt vmcnt(0)
  v_mfma_f32_32x32x16_bf16 v[16:31], v[72:75], v[76:79], v[16:31]
  v_sub_f32 v7, 1.0, v7
  s_nop 15
  s_nop 3
  v_mul_f32 v16, v16, v7
  v_mul_f32 v17, v17, v7
  v_mul_f32 v18, v18, v7
  v_mul_f32 v19, v19, v7
  v_mul_f32 v20, v20, v7
  v_mul_f32 v21, v21, v7
  v_mul_f32 v22, v22, v7
  v_mul_f32 v23, v23, v7
  v_mul_f32 v24, v24, v7
  v_mul_f32 v25, v25, v7
  v_mul_f32 v26, v26, v7
  v_mul_f32 v27, v27, v7
  v_mul_f32 v28, v28, v7
  v_mul_f32 v29, v29, v7
  v_mul_f32 v30, v30, v7
  v_mul_f32 v31, v31, v7
  s_lshl_b32 s60, s58, 4
  s_add_u32 s60, s60, s59
  s_lshl_b32 s60, s60, 11
  s_add_u32 s60, s60, 20971520
  v_cvt_pk_bf16_f32 v32, v16, v17
  v_cvt_pk_bf16_f32 v33, v18, v19
  v_cvt_pk_bf16_f32 v34, v20, v21
  v_cvt_pk_bf16_f32 v35, v22, v23
  v_cvt_pk_bf16_f32 v36, v24, v25
  v_cvt_pk_bf16_f32 v37, v26, v27
  v_cvt_pk_bf16_f32 v38, v28, v29
  v_cvt_pk_bf16_f32 v39, v30, v31
  s_nop 1
  buffer_store_dwordx4 v[32:35], v4, s[36:39], s60 offen offset:0 sc1
  buffer_store_dwordx4 v[36:39], v4, s[36:39], s60 offen offset:1024 sc1
k2_attn_kernel_end:
  s_endpgm
.globl gated_mix__softmax_full_mha__swiglu_ffn__prompt_kernel
.p2align 8
.type gated_mix__softmax_full_mha__swiglu_ffn__prompt_kernel,@function
gated_mix__softmax_full_mha__swiglu_ffn__prompt_kernel:
  s_cmp_ge_u32 s2, 256
  s_cbranch_scc1 gated_mix__softmax_full_mha__swiglu_ffn__prompt_kernel_end
  s_load_dwordx2 s[4:5], s[0:1], 64
  s_load_dwordx2 s[6:7], s[0:1], 80
  v_and_b32 v1, 63, v0
  v_lshrrev_b32 v2, 6, v0
  s_nop 0
  v_readfirstlane_b32 s48, v2
  s_and_b32 s49, s2, 7
  s_lshr_b32 s50, s2, 3
  s_and_b32 s51, s50, 3
  s_lshl_b32 s52, s49, 2
  s_add_u32 s51, s51, s52
  s_lshr_b32 s52, s50, 2
  v_lshlrev_b32 v4, 4, v1
  s_and_b32 s61, s48, 1
  s_lshr_b32 s62, s48, 1
  s_lshl_b32 s63, s51, 1
  s_add_u32 s63, s63, s61
  s_lshl_b32 s64, s52, 1
  s_add_u32 s64, s64, s62
  s_lshl_b32 s53, s48, 3
  s_xor_b32 s55, s63, 0
  s_mul_i32 s55, s55, 118
  s_add_u32 s55, s55, s53
  s_lshl_b32 s55, s55, 10
  s_add_u32 s55, s55, 6291456
  s_xor_b32 s56, s63, 1
  s_mul_i32 s56, s56, 118
  s_add_u32 s56, s56, s53
  s_lshl_b32 s56, s56, 10
  s_add_u32 s56, s56, 6291456
  s_xor_b32 s57, s64, 0
  s_mul_i32 s57, s57, 118
  s_add_u32 s57, s57, s53
  s_lshl_b32 s57, s57, 10
  s_add_u32 s57, s57, 17825792
  s_xor_b32 s58, s64, 1
  s_mul_i32 s58, s58, 118
  s_add_u32 s58, s58, s53
  s_lshl_b32 s58, s58, 10
  s_add_u32 s58, s58, 17825792
  s_lshl_b32 s59, s63, 4
  s_add_u32 s59, s59, s64
  s_lshl_b32 s59, s59, 11
  s_add_u32 s59, s59, 20971520
  s_waitcnt lgkmcnt(0)
  s_mov_b32 s28, s4
  s_and_b32 s29, s5, 0xffff
  s_mov_b32 s30, 2097152
  s_mov_b32 s31, 0x00020000
  s_mov_b32 s36, s6
  s_and_b32 s37, s7, 0xffff
  s_mov_b32 s38, 33554432
  s_mov_b32 s39, 0x00020000
  buffer_load_dwordx4 v[24:27], v4, s[36:39], s59 offen offset:0
  buffer_load_dwordx4 v[28:31], v4, s[36:39], s59 offen offset:1024
  buffer_load_dwordx4 v[80:83], v4, s[36:39], s55 offen offset:0
  buffer_load_dwordx4 v[88:91], v4, s[36:39], s57 offen offset:0
  buffer_load_dwordx4 v[84:87], v4, s[36:39], s56 offen offset:0
  buffer_load_dwordx4 v[92:95], v4, s[36:39], s58 offen offset:0
  buffer_load_dwordx4 v[96:99], v4, s[36:39], s55 offen offset:1024
  buffer_load_dwordx4 v[104:107], v4, s[36:39], s57 offen offset:1024
  buffer_load_dwordx4 v[100:103], v4, s[36:39], s56 offen offset:1024
  buffer_load_dwordx4 v[108:111], v4, s[36:39], s58 offen offset:1024
  buffer_load_dwordx4 v[112:115], v4, s[36:39], s55 offen offset:2048
  buffer_load_dwordx4 v[120:123], v4, s[36:39], s57 offen offset:2048
  buffer_load_dwordx4 v[116:119], v4, s[36:39], s56 offen offset:2048
  buffer_load_dwordx4 v[124:127], v4, s[36:39], s58 offen offset:2048
  buffer_load_dwordx4 v[128:131], v4, s[36:39], s55 offen offset:3072
  buffer_load_dwordx4 v[136:139], v4, s[36:39], s57 offen offset:3072
  buffer_load_dwordx4 v[132:135], v4, s[36:39], s56 offen offset:3072
  buffer_load_dwordx4 v[140:143], v4, s[36:39], s58 offen offset:3072
  s_add_u32 s55, s55, 4096
  s_add_u32 s56, s56, 4096
  s_add_u32 s57, s57, 4096
  s_add_u32 s58, s58, 4096
  buffer_load_dwordx4 v[144:147], v4, s[36:39], s55 offen offset:0
  buffer_load_dwordx4 v[152:155], v4, s[36:39], s57 offen offset:0
  buffer_load_dwordx4 v[148:151], v4, s[36:39], s56 offen offset:0
  buffer_load_dwordx4 v[156:159], v4, s[36:39], s58 offen offset:0
  buffer_load_dwordx4 v[160:163], v4, s[36:39], s55 offen offset:1024
  buffer_load_dwordx4 v[168:171], v4, s[36:39], s57 offen offset:1024
  buffer_load_dwordx4 v[164:167], v4, s[36:39], s56 offen offset:1024
  buffer_load_dwordx4 v[172:175], v4, s[36:39], s58 offen offset:1024
  buffer_load_dwordx4 v[176:179], v4, s[36:39], s55 offen offset:2048
  buffer_load_dwordx4 v[184:187], v4, s[36:39], s57 offen offset:2048
  buffer_load_dwordx4 v[180:183], v4, s[36:39], s56 offen offset:2048
  buffer_load_dwordx4 v[188:191], v4, s[36:39], s58 offen offset:2048
  buffer_load_dwordx4 v[192:195], v4, s[36:39], s55 offen offset:3072
  buffer_load_dwordx4 v[200:203], v4, s[36:39], s57 offen offset:3072
  buffer_load_dwordx4 v[196:199], v4, s[36:39], s56 offen offset:3072
  buffer_load_dwordx4 v[204:207], v4, s[36:39], s58 offen offset:3072
  s_xor_b32 s66, s48, 1
  s_mul_i32 s66, s66, 12288
  s_add_u32 s66, s66, 0
  v_add_u32 v6, s66, v4
  s_xor_b32 s66, s48, 2
  s_mul_i32 s66, s66, 12288
  s_add_u32 s66, s66, 4096
  v_add_u32 v7, s66, v4
  s_xor_b32 s66, s48, 3
  s_mul_i32 s66, s66, 12288
  s_add_u32 s66, s66, 8192
  v_add_u32 v8, s66, v4
  s_mul_i32 s66, s48, 12288
  v_add_u32 v9, s66, v4
  v_and_b32 v11, 31, v1
  v_lshrrev_b32 v12, 5, v1
  s_lshl_b32 s59, s63, 15
  s_lshl_b32 s60, s64, 6
  s_add_u32 s59, s59, s60
  v_lshlrev_b32 v10, 10, v11
  v_lshl_add_u32 v10, v12, 4, v10
  s_waitcnt vmcnt(28)
  v_lshlrev_b32 v16, 16, v24
  v_and_b32 v17, 0xffff0000, v24
  v_lshlrev_b32 v18, 16, v25
  v_and_b32 v19, 0xffff0000, v25
  v_lshlrev_b32 v20, 16, v26
  v_and_b32 v21, 0xffff0000, v26
  v_lshlrev_b32 v22, 16, v27
  v_and_b32 v23, 0xffff0000, v27
  v_lshlrev_b32 v24, 16, v28
  v_and_b32 v25, 0xffff0000, v28
  v_lshlrev_b32 v26, 16, v29
  v_and_b32 v27, 0xffff0000, v29
  v_lshlrev_b32 v28, 16, v30
  v_and_b32 v29, 0xffff0000, v30
  v_lshlrev_b32 v30, 16, v31
  v_and_b32 v31, 0xffff0000, v31
  v_mfma_f32_32x32x16_bf16 v[32:47], v[88:91], v[84:87], 0
  v_mfma_f32_32x32x16_bf16 v[48:63], v[92:95], v[80:83], 0
  v_mfma_f32_32x32x16_bf16 v[64:79], v[92:95], v[84:87], 0
  v_mfma_f32_32x32x16_bf16 v[16:31], v[88:91], v[80:83], v[16:31]
  s_waitcnt vmcnt(24)
  v_mfma_f32_32x32x16_bf16 v[16:31], v[104:107], v[96:99], v[16:31]
  v_mfma_f32_32x32x16_bf16 v[32:47], v[104:107], v[100:103], v[32:47]
  v_mfma_f32_32x32x16_bf16 v[48:63], v[108:111], v[96:99], v[48:63]
  v_mfma_f32_32x32x16_bf16 v[64:79], v[108:111], v[100:103], v[64:79]
  s_waitcnt vmcnt(20)
  v_mfma_f32_32x32x16_bf16 v[16:31], v[120:123], v[112:115], v[16:31]
  v_mfma_f32_32x32x16_bf16 v[32:47], v[120:123], v[116:119], v[32:47]
  v_mfma_f32_32x32x16_bf16 v[48:63], v[124:127], v[112:115], v[48:63]
  v_mfma_f32_32x32x16_bf16 v[64:79], v[124:127], v[116:119], v[64:79]
  s_waitcnt vmcnt(16)
  v_mfma_f32_32x32x16_bf16 v[16:31], v[136:139], v[128:131], v[16:31]
  v_mfma_f32_32x32x16_bf16 v[32:47], v[136:139], v[132:135], v[32:47]
  v_mfma_f32_32x32x16_bf16 v[48:63], v[140:143], v[128:131], v[48:63]
  v_mfma_f32_32x32x16_bf16 v[64:79], v[140:143], v[132:135], v[64:79]
  s_waitcnt vmcnt(12)
  v_mfma_f32_32x32x16_bf16 v[16:31], v[152:155], v[144:147], v[16:31]
  v_mfma_f32_32x32x16_bf16 v[32:47], v[152:155], v[148:151], v[32:47]
  v_mfma_f32_32x32x16_bf16 v[48:63], v[156:159], v[144:147], v[48:63]
  v_mfma_f32_32x32x16_bf16 v[64:79], v[156:159], v[148:151], v[64:79]
  s_waitcnt vmcnt(8)
  v_mfma_f32_32x32x16_bf16 v[16:31], v[168:171], v[160:163], v[16:31]
  v_mfma_f32_32x32x16_bf16 v[32:47], v[168:171], v[164:167], v[32:47]
  v_mfma_f32_32x32x16_bf16 v[48:63], v[172:175], v[160:163], v[48:63]
  v_mfma_f32_32x32x16_bf16 v[64:79], v[172:175], v[164:167], v[64:79]
  s_waitcnt vmcnt(4)
  v_mfma_f32_32x32x16_bf16 v[16:31], v[184:187], v[176:179], v[16:31]
  v_mfma_f32_32x32x16_bf16 v[32:47], v[184:187], v[180:183], v[32:47]
  v_mfma_f32_32x32x16_bf16 v[48:63], v[188:191], v[176:179], v[48:63]
  v_mfma_f32_32x32x16_bf16 v[64:79], v[188:191], v[180:183], v[64:79]
  s_waitcnt vmcnt(0)
  v_mfma_f32_32x32x16_bf16 v[16:31], v[200:203], v[192:195], v[16:31]
  v_mfma_f32_32x32x16_bf16 v[32:47], v[200:203], v[196:199], v[32:47]
  v_mfma_f32_32x32x16_bf16 v[48:63], v[204:207], v[192:195], v[48:63]
  v_mfma_f32_32x32x16_bf16 v[64:79], v[204:207], v[196:199], v[64:79]
  s_nop 7
  s_nop 1
  ds_write_b128 v6, v[32:35] offset:0
  ds_write_b128 v6, v[36:39] offset:1024
  ds_write_b128 v6, v[40:43] offset:2048
  ds_write_b128 v6, v[44:47] offset:3072
  ds_write_b128 v7, v[48:51] offset:0
  ds_write_b128 v7, v[52:55] offset:1024
  ds_write_b128 v7, v[56:59] offset:2048
  ds_write_b128 v7, v[60:63] offset:3072
  s_nop 7
  ds_write_b128 v8, v[64:67] offset:0
  ds_write_b128 v8, v[68:71] offset:1024
  ds_write_b128 v8, v[72:75] offset:2048
  ds_write_b128 v8, v[76:79] offset:3072
  s_waitcnt lgkmcnt(0)
  s_barrier
  ds_read_b128 v[80:83], v9 offset:0
  ds_read_b128 v[84:87], v9 offset:1024
  ds_read_b128 v[88:91], v9 offset:2048
  ds_read_b128 v[92:95], v9 offset:3072
  ds_read_b128 v[96:99], v9 offset:4096
  ds_read_b128 v[100:103], v9 offset:5120
  ds_read_b128 v[104:107], v9 offset:6144
  ds_read_b128 v[108:111], v9 offset:7168
  ds_read_b128 v[112:115], v9 offset:8192
  ds_read_b128 v[116:119], v9 offset:9216
  ds_read_b128 v[120:123], v9 offset:10240
  ds_read_b128 v[124:127], v9 offset:11264
  s_waitcnt lgkmcnt(8)
  v_pk_add_f32 v[16:17], v[16:17], v[80:81]
  v_pk_add_f32 v[18:19], v[18:19], v[82:83]
  v_pk_add_f32 v[20:21], v[20:21], v[84:85]
  v_pk_add_f32 v[22:23], v[22:23], v[86:87]
  v_pk_add_f32 v[24:25], v[24:25], v[88:89]
  v_pk_add_f32 v[26:27], v[26:27], v[90:91]
  v_pk_add_f32 v[28:29], v[28:29], v[92:93]
  v_pk_add_f32 v[30:31], v[30:31], v[94:95]
  s_waitcnt lgkmcnt(4)
  v_pk_add_f32 v[16:17], v[16:17], v[96:97]
  v_pk_add_f32 v[18:19], v[18:19], v[98:99]
  v_pk_add_f32 v[20:21], v[20:21], v[100:101]
  v_pk_add_f32 v[22:23], v[22:23], v[102:103]
  v_pk_add_f32 v[24:25], v[24:25], v[104:105]
  v_pk_add_f32 v[26:27], v[26:27], v[106:107]
  v_pk_add_f32 v[28:29], v[28:29], v[108:109]
  v_pk_add_f32 v[30:31], v[30:31], v[110:111]
  s_waitcnt lgkmcnt(0)
  v_pk_add_f32 v[16:17], v[16:17], v[112:113]
  v_pk_add_f32 v[18:19], v[18:19], v[114:115]
  v_pk_add_f32 v[20:21], v[20:21], v[116:117]
  v_pk_add_f32 v[22:23], v[22:23], v[118:119]
  v_pk_add_f32 v[24:25], v[24:25], v[120:121]
  v_pk_add_f32 v[26:27], v[26:27], v[122:123]
  v_pk_add_f32 v[28:29], v[28:29], v[124:125]
  v_pk_add_f32 v[30:31], v[30:31], v[126:127]
  v_cvt_pk_bf16_f32 v80, v16, v17
  v_cvt_pk_bf16_f32 v81, v18, v19
  v_cvt_pk_bf16_f32 v82, v20, v21
  v_cvt_pk_bf16_f32 v83, v22, v23
  v_cvt_pk_bf16_f32 v84, v24, v25
  v_cvt_pk_bf16_f32 v85, v26, v27
  v_cvt_pk_bf16_f32 v86, v28, v29
  v_cvt_pk_bf16_f32 v87, v30, v31
  s_nop 1
  v_permlane32_swap_b32 v80, v82
  v_permlane32_swap_b32 v81, v83
  v_permlane32_swap_b32 v84, v86
  v_permlane32_swap_b32 v85, v87
  s_nop 1
  buffer_store_dwordx4 v[80:83], v10, s[28:31], s59 offen
  buffer_store_dwordx4 v[84:87], v10, s[28:31], s59 offen offset:32
gated_mix__softmax_full_mha__swiglu_ffn__prompt_kernel_end:
  s_endpgm
.section .rodata,"a"
.p2align 6
.amdhsa_kernel k1_qkv_kernel
  .amdhsa_next_free_vgpr 168
  .amdhsa_next_free_sgpr 102
  .amdhsa_accum_offset 168
  .amdhsa_group_segment_fixed_size 0
  .amdhsa_kernarg_size 88
  .amdhsa_user_sgpr_count 2
  .amdhsa_user_sgpr_kernarg_segment_ptr 1
  .amdhsa_system_sgpr_workgroup_id_x 1
.end_amdhsa_kernel
.p2align 6
.amdhsa_kernel k2_attn_kernel
  .amdhsa_next_free_vgpr 168
  .amdhsa_next_free_sgpr 102
  .amdhsa_accum_offset 168
  .amdhsa_group_segment_fixed_size 0
  .amdhsa_kernarg_size 88
  .amdhsa_user_sgpr_count 2
  .amdhsa_user_sgpr_kernarg_segment_ptr 1
  .amdhsa_system_sgpr_workgroup_id_x 1
.end_amdhsa_kernel
.p2align 6
.amdhsa_kernel gated_mix__softmax_full_mha__swiglu_ffn__prompt_kernel
  .amdhsa_next_free_vgpr 208
  .amdhsa_next_free_sgpr 102
  .amdhsa_accum_offset 208
  .amdhsa_group_segment_fixed_size 0
  .amdhsa_kernarg_size 88
  .amdhsa_user_sgpr_count 2
  .amdhsa_user_sgpr_kernarg_segment_ptr 1
  .amdhsa_system_sgpr_workgroup_id_x 1
.end_amdhsa_kernel
```
